```python
import torch

def _softmax(x, axis=-1):
    return torch.softmax(x, dim=axis)
def _gelu(x):
    return torch.nn.functional.gelu(x, approximate="tanh")
def _silu(x):
    return torch.nn.functional.silu(x)
def _sigmoid(x):
    return torch.sigmoid(x)
def _layernorm(x, axis=-1, eps=1e-5):
    m = x.mean(dim=axis, keepdim=True)
    v = x.var(dim=axis, keepdim=True, unbiased=False)
    return (x - m) / torch.sqrt(v + eps)
def _scatter_add(tgt, idx, src, axis=0):
    return tgt.clone().index_add_(axis, idx, src)
def _segment_sum(src, seg, n):
    out = torch.zeros((n,) + src.shape[1:], dtype=src.dtype)
    return out.index_add_(0, seg, src)
def _pad(x, pw):
    flat = tuple(v for pair in reversed(pw) for v in pair)
    return torch.nn.functional.pad(x, flat)

kernel_name = 'recurrent_scan__ssm_conv_s5__geglu_ffn__prompt'

def setup_inputs():

    _w = (lambda a: (lambda t: t.to(torch.bfloat16) if t.is_floating_point() else t)(torch.as_tensor(a)))
    def _A_setup():
        B, S, D = 1, 2048, 640
        P = D
        Lambda_re = -0.5 * (lambda _x: torch.exp(torch.as_tensor(_x)))((lambda *s: torch.randn(*s, dtype=torch.bfloat16) * 0.2)(P))
        Lambda_im = (lambda *s: torch.randn(*s, dtype=torch.bfloat16) * 0.4)(P) * 1.0
        B_re = (lambda *s: torch.randn(*s, dtype=torch.bfloat16) * 0.2)(P, D) * (D ** -0.5)
        B_im = (lambda *s: torch.randn(*s, dtype=torch.bfloat16) * 0.2)(P, D) * (D ** -0.5)
        C_re = (lambda *s: torch.randn(*s, dtype=torch.bfloat16) * 0.2)(D, P) * (P ** -0.5)
        C_im = (lambda *s: torch.randn(*s, dtype=torch.bfloat16) * 0.2)(D, P) * (P ** -0.5)
        log_dt = (lambda *s: torch.randn(*s, dtype=torch.bfloat16) * 0.2)(P) * 0.3 - 2.0
        Dskip = (lambda *s: torch.randn(*s, dtype=torch.bfloat16) * 0.05)(D)
        return {
            "x": _w((lambda *s: torch.randn(*s, dtype=torch.bfloat16) * 0.05)(B, S, D)),
            "Lambda_re": _w(Lambda_re),
            "Lambda_im": _w(Lambda_im),
            "B_re": _w(B_re),
            "B_im": _w(B_im),
            "C_re": _w(C_re),
            "C_im": _w(C_im),
            "log_dt": _w(log_dt),
            "Dskip": _w(Dskip),
        }
    _A_in = _A_setup()

    def _B_setup():
        B, S, D, F = 1, 2048, 640, 1728
        return {
            "x": _w((lambda *s: torch.randn(*s, dtype=torch.bfloat16) * 0.05)(B, S, D)),
            "w_gate": _w((lambda *s: torch.randn(*s, dtype=torch.bfloat16) * 0.05)(D, F)),
            "w_up": _w((lambda *s: torch.randn(*s, dtype=torch.bfloat16) * 0.05)(D, F)),
            "w_down": _w((lambda *s: torch.randn(*s, dtype=torch.bfloat16) * 0.05)(F, D)),
        }
    _B_in = _B_setup()

    return {
        "A_x": _A_in["x"],
        "A_Lambda_re": _A_in["Lambda_re"],
        "A_Lambda_im": _A_in["Lambda_im"],
        "A_B_re": _A_in["B_re"],
        "A_B_im": _A_in["B_im"],
        "A_C_re": _A_in["C_re"],
        "A_C_im": _A_in["C_im"],
        "A_log_dt": _A_in["log_dt"],
        "A_Dskip": _A_in["Dskip"],
        "B_x": _B_in["x"],
        "B_w_gate": _B_in["w_gate"],
        "B_w_up": _B_in["w_up"],
        "B_w_down": _B_in["w_down"],
    }

def reference(A_x, A_Lambda_re, A_Lambda_im, A_B_re, A_B_im, A_C_re, A_C_im, A_log_dt, A_Dskip, B_x, B_w_gate, B_w_up, B_w_down):
    def _A_ref(x, Lambda_re, Lambda_im, B_re, B_im, C_re, C_im, log_dt, Dskip):
        Bsz, L, H = x.shape
        Lam = Lambda_re + 1j * Lambda_im
        Bmat = B_re + 1j * B_im
        Cmat = C_re + 1j * C_im
        dt = torch.exp(log_dt)
        Lam_bar = torch.exp(dt * Lam)
        B_bar = ((Lam_bar - 1.0) / Lam)[:, None] * Bmat
        Bu = torch.einsum("bld,pd->blp", x + 0j, B_bar)
        h = torch.zeros_like(Bu[:, 0, :])
        hs = []
        for t in range(L):
            h = Lam_bar[None, :] * h + Bu[:, t, :]
            hs.append(h)
        hseq = torch.stack(hs, 1)
        y = 2.0 * torch.einsum("blp,dp->bld", hseq, Cmat).real + x * Dskip[None, None, :]
        return y

    def _B_ref(x, w_gate, w_up, w_down):
        return (_gelu(x @ w_gate) * (x @ w_up)) @ w_down

    x = A_x
    xn = _layernorm(x, axis=-1)
    s = _A_ref(xn, A_Lambda_re, A_Lambda_im, A_B_re, A_B_im, A_C_re, A_C_im, A_log_dt, A_Dskip)
    g = _silu(_B_ref(xn, B_w_gate, B_w_up, B_w_down))
    return x + s * g
```

```asm
; @launch grid=(256,1,1) block=(512,1,1) lds=163840
.amdgcn_target "amdgcn-amd-amdhsa--gfx950"
.text
.globl recurrent_scan__ssm_conv_s5__geglu_ffn__prompt_kernel
.p2align 8
.type recurrent_scan__ssm_conv_s5__geglu_ffn__prompt_kernel,@function
recurrent_scan__ssm_conv_s5__geglu_ffn__prompt_kernel:
    s_cmp_ge_u32 s2, 256
    s_cbranch_scc1 K1_END
    s_load_dwordx16 s[16:31], s[0:1], 0
    s_load_dwordx16 s[32:47], s[0:1], 64
    v_lshrrev_b32 v1, 6, v0
    v_and_b32 v2, 63, v0
    s_and_b32 s8, s2, 7
    v_readfirstlane_b32 s3, v1
    s_lshr_b32 s9, s2, 3
    s_lshr_b32 s6, s8, 1
    s_lshl_b32 s6, s6, 2
    s_and_b32 s10, s9, 3
    s_add_u32 s6, s6, s10
    s_and_b32 s7, s8, 1
    s_lshl_b32 s7, s7, 3
    s_lshr_b32 s10, s9, 2
    s_add_u32 s7, s7, s10
    s_and_b32 s4, s3, 3
    s_lshr_b32 s5, s3, 2
    s_add_u32 s11, s6, s7
    s_sub_u32 s12, s11, 10
    s_cmp_ge_u32 s11, 10
    s_cselect_b32 s11, s12, s11
    s_sub_u32 s12, s11, 10
    s_cmp_ge_u32 s11, 10
    s_cselect_b32 s11, s12, s11
    s_sub_u32 s12, s11, 10
    s_cmp_ge_u32 s11, 10
    s_cselect_b32 s11, s12, s11
    s_mov_b32 s0, s11
    s_lshl_b32 s10, s6, 7
    s_lshl_b32 s11, s3, 4
    s_add_u32 s10, s10, s11
    v_lshrrev_b32 v3, 3, v2
    v_add_u32 v4, s10, v3
    v_mul_u32_u24 v8, 1280, v4
    v_and_b32 v5, 7, v2
    v_lshrrev_b32 v6, 4, v2
    v_xor_b32 v26, v5, v6
    v_xor_b32 v27, 4, v26
    v_add_u32 v9, 10240, v8
    v_lshl_add_u32 v8, v26, 4, v8
    v_lshl_add_u32 v9, v27, 4, v9
    v_mov_b32 v18, 0x3f803f80
    s_lshl_b32 s69, s3, 11
    s_lshl_b32 s74, s0, 7
    s_waitcnt lgkmcnt(0)
    s_mov_b32 s48, s16
    s_mov_b32 s49, s17
    s_mov_b32 s50, 2621440
    s_mov_b32 s51, 0x20000
    s_or_b32 s10, s2, s3
    s_cmp_eq_u32 s10, 0
    s_cbranch_scc0 K1_NONC
    s_memrealtime s[92:93]
    s_waitcnt lgkmcnt(0)
    s_or_b32 s92, s92, 1
    v_mov_b32 v3, s92
    v_mov_b32 v4, 0
    global_store_dword v4, v3, s[44:45] sc1
K1_NONC:
    s_cmp_lt_u32 s3, 6
    s_cbranch_scc1 K1_NOSJ
    s_lshl_b32 s10, s2, 3
    s_sub_u32 s11, s3, 6
    s_lshl_b32 s11, s11, 2
    s_add_u32 s10, s10, s11
    v_add_u32 v28, s10, v6
    v_mul_u32_u24 v3, 1280, v28
    v_and_b32 v4, 15, v2
    v_lshl_add_u32 v3, v4, 4, v3
    buffer_load_dwordx4 v[208:211], v3, s[48:51], 0 offen offset:0
    buffer_load_dwordx4 v[212:215], v3, s[48:51], 0 offen offset:256
    buffer_load_dwordx4 v[216:219], v3, s[48:51], 0 offen offset:512
    buffer_load_dwordx4 v[220:223], v3, s[48:51], 0 offen offset:768
    buffer_load_dwordx4 v[224:227], v3, s[48:51], 0 offen offset:1024
K1_NOSJ:
    s_add_u32 s64, s46, 4194304
    s_addc_u32 s65, s47, 0
    s_mov_b32 s66, 12320768
    s_mov_b32 s67, 0x20000
    s_add_u32 s96, s46, 20971520
    s_addc_u32 s97, s47, 0
    s_mov_b32 s98, 3850240
    s_mov_b32 s99, 0x20000
    s_cmp_ge_u32 s7, 11
    s_cbranch_scc1 K1_SSM
    s_mov_b32 s79, 0
    s_add_u32 m0, s79, s69
    s_nop 0
    buffer_load_dwordx4 v8, s[48:51], s74 offen lds
    s_add_u32 m0, m0, 1024
    s_nop 0
    buffer_load_dwordx4 v9, s[48:51], s74 offen lds
    s_add_u32 s74, s74, 128
    s_cmp_ge_u32 s74, 1280
    s_cselect_b32 s74, 0, s74
    s_add_u32 s79, s79, 16384
    s_cmp_ge_u32 s79, 49152
    s_cselect_b32 s79, 0, s79
    s_mov_b32 s52, s36
    s_mov_b32 s53, s37
    s_mov_b32 s54, 2211840
    s_mov_b32 s55, 0x20000
    s_cmp_lt_u32 s3, 2
    s_cselect_b32 s56, s36, s38
    s_cselect_b32 s57, s37, s39
    s_mov_b32 s58, 2211840
    s_mov_b32 s59, 0x20000
    s_mov_b32 s60, s38
    s_mov_b32 s61, s39
    s_mov_b32 s62, 2211840
    s_mov_b32 s63, 0x20000
    s_add_u32 s10, s3, 8
    s_sub_u32 s11, s3, 2
    s_cmp_lt_u32 s3, 2
    s_cselect_b32 s10, s10, s11
    s_mov_b32 s12, 10272
    s_cselect_b32 s11, 0, s12
    s_lshl_b32 s12, s10, 10
    s_add_u32 s71, s12, s11
    s_lshl_b32 s70, s3, 10
    s_add_u32 s72, s70, 16416
    s_lshl_b32 s12, s3, 6
    v_add_u32 v3, s12, v2
    s_mov_b32 s13, 214748365
    v_mul_hi_u32 v4, v3, s13
    v_mul_u32_u24 v5, 20, v4
    v_sub_u32 v5, v3, v5
    v_mul_u32_u24 v4, 3456, v4
    v_lshl_add_u32 v10, v5, 4, v4
    s_lshl_b32 s12, s10, 6
    v_add_u32 v3, s12, v2
    s_mov_b32 s13, 214748365
    v_mul_hi_u32 v4, v3, s13
    v_mul_u32_u24 v5, 20, v4
    v_sub_u32 v5, v3, v5
    v_mul_u32_u24 v4, 3456, v4
    v_lshl_add_u32 v11, v5, 4, v4
    s_add_u32 s11, s3, 6
    s_lshl_b32 s12, s11, 6
    v_add_u32 v3, s12, v2
    s_mov_b32 s13, 214748365
    v_mul_hi_u32 v4, v3, s13
    v_mul_u32_u24 v5, 20, v4
    v_sub_u32 v5, v3, v5
    v_mul_u32_u24 v4, 3456, v4
    v_lshl_add_u32 v12, v5, 4, v4
    s_mul_i32 s1, s7, 320
    s_mul_i32 s73, s0, 221184
    s_add_u32 s73, s73, s1
    s_add_u32 s1, s1, 2211840
    s_mov_b32 s75, 49152
    s_add_u32 m0, s75, s70
    s_nop 0
    buffer_load_dwordx4 v10, s[52:55], s73 offen lds
    s_add_u32 m0, s75, s71
    s_nop 0
    buffer_load_dwordx4 v11, s[56:59], s73 offen lds
    s_cmp_lt_u32 s3, 4
    s_cbranch_scc0 K1F3_1
    s_add_u32 m0, s75, s72
    s_nop 0
    buffer_load_dwordx4 v12, s[60:63], s73 offen lds
K1F3_1:
    s_add_u32 s73, s73, 110592
    s_sub_u32 s12, s73, 2211840
    s_cmp_ge_u32 s73, s1
    s_cselect_b32 s73, s12, s73
    s_add_u32 s75, s75, 20544
    s_cmp_ge_u32 s75, 151872
    s_cselect_b32 s75, 49152, s75
    s_barrier
    s_add_u32 m0, s75, s70
    s_nop 0
    buffer_load_dwordx4 v10, s[52:55], s73 offen lds
    s_add_u32 m0, s75, s71
    s_nop 0
    buffer_load_dwordx4 v11, s[56:59], s73 offen lds
    s_cmp_lt_u32 s3, 4
    s_cbranch_scc0 K1F3_2
    s_add_u32 m0, s75, s72
    s_nop 0
    buffer_load_dwordx4 v12, s[60:63], s73 offen lds
K1F3_2:
    s_add_u32 s73, s73, 110592
    s_sub_u32 s12, s73, 2211840
    s_cmp_ge_u32 s73, s1
    s_cselect_b32 s73, s12, s73
    s_add_u32 s75, s75, 20544
    s_cmp_ge_u32 s75, 151872
    s_cselect_b32 s75, 49152, s75
    v_and_b32 v3, 31, v2
    s_lshl_b32 s10, s4, 5
    v_add_u32 v4, s10, v3
    v_lshlrev_b32 v13, 7, v4
    v_bfe_u32 v5, v2, 1, 3
    v_lshrrev_b32 v4, 5, v2
    v_xor_b32 v4, v4, v5
    v_lshl_add_u32 v13, v4, 4, v13
    v_lshrrev_b32 v3, 5, v2
    v_lshlrev_b32 v3, 3, v3
    v_bfe_u32 v4, v2, 2, 2
    v_add_u32 v3, v3, v4
    v_mul_u32_u24 v14, 320, v3
    v_and_b32 v4, 3, v2
    v_lshl_add_u32 v14, v4, 3, v14
    v_bfe_u32 v4, v2, 4, 1
    v_mul_u32_u24 v4, 10272, v4
    v_add_u32 v14, v14, v4
    s_mul_i32 s10, s5, 160
    v_add_u32 v14, s10, v14
    v_mov_b32 v128, 0
    v_mov_b32 v129, 0
    v_mov_b32 v130, 0
    v_mov_b32 v131, 0
    v_mov_b32 v132, 0
    v_mov_b32 v133, 0
    v_mov_b32 v134, 0
    v_mov_b32 v135, 0
    v_mov_b32 v136, 0
    v_mov_b32 v137, 0
    v_mov_b32 v138, 0
    v_mov_b32 v139, 0
    v_mov_b32 v140, 0
    v_mov_b32 v141, 0
    v_mov_b32 v142, 0
    v_mov_b32 v143, 0
    v_mov_b32 v144, 0
    v_mov_b32 v145, 0
    v_mov_b32 v146, 0
    v_mov_b32 v147, 0
    v_mov_b32 v148, 0
    v_mov_b32 v149, 0
    v_mov_b32 v150, 0
    v_mov_b32 v151, 0
    v_mov_b32 v152, 0
    v_mov_b32 v153, 0
    v_mov_b32 v154, 0
    v_mov_b32 v155, 0
    v_mov_b32 v156, 0
    v_mov_b32 v157, 0
    v_mov_b32 v158, 0
    v_mov_b32 v159, 0
    v_mov_b32 v160, 0
    v_mov_b32 v161, 0
    v_mov_b32 v162, 0
    v_mov_b32 v163, 0
    v_mov_b32 v164, 0
    v_mov_b32 v165, 0
    v_mov_b32 v166, 0
    v_mov_b32 v167, 0
    v_mov_b32 v168, 0
    v_mov_b32 v169, 0
    v_mov_b32 v170, 0
    v_mov_b32 v171, 0
    v_mov_b32 v172, 0
    v_mov_b32 v173, 0
    v_mov_b32 v174, 0
    v_mov_b32 v175, 0
    v_mov_b32 v176, 0
    v_mov_b32 v177, 0
    v_mov_b32 v178, 0
    v_mov_b32 v179, 0
    v_mov_b32 v180, 0
    v_mov_b32 v181, 0
    v_mov_b32 v182, 0
    v_mov_b32 v183, 0
    v_mov_b32 v184, 0
    v_mov_b32 v185, 0
    v_mov_b32 v186, 0
    v_mov_b32 v187, 0
    v_mov_b32 v188, 0
    v_mov_b32 v189, 0
    v_mov_b32 v190, 0
    v_mov_b32 v191, 0
    v_mov_b32 v192, 0
    v_mov_b32 v193, 0
    v_mov_b32 v194, 0
    v_mov_b32 v195, 0
    v_mov_b32 v196, 0
    v_mov_b32 v197, 0
    v_mov_b32 v198, 0
    v_mov_b32 v199, 0
    v_mov_b32 v200, 0
    v_mov_b32 v201, 0
    v_mov_b32 v202, 0
    v_mov_b32 v203, 0
    v_mov_b32 v204, 0
    v_mov_b32 v205, 0
    v_mov_b32 v206, 0
    v_mov_b32 v207, 0
    s_cmp_eq_u32 s4, s5
    s_cselect_b32 s68, 1, 0
    s_cmp_lt_u32 s6, 10
    s_cselect_b32 s68, s68, 0
    s_mul_i32 s10, s6, 11
    s_add_u32 s10, s10, s7
    s_lshl_b32 s10, s10, 3
    s_add_u32 s10, s10, s3
    s_mul_hi_u32 s11, s10, 21474837
    s_mul_i32 s12, s11, 200
    s_sub_u32 s12, s10, s12
    s_mul_hi_u32 s13, s12, 858993460
    s_mul_i32 s15, s13, 5
    s_sub_u32 s15, s12, s15
    s_and_b32 s91, s13, 1
    s_mul_i32 s100, s11, 94
    s_add_u32 s100, s100, s13
    s_mul_i32 s100, s100, 5
    s_add_u32 s100, s100, s15
    s_lshl_b32 s100, s100, 10
    s_mul_i32 s11, s11, 80
    s_lshl_b32 s15, s15, 4
    s_add_u32 s15, s15, s11
    v_lshrrev_b32 v3, 2, v2
    v_add_u32 v3, s15, v3
    v_mul_u32_u24 v3, 1280, v3
    v_and_b32 v4, 3, v2
    v_lshl_add_u32 v232, v4, 4, v3
    s_lshr_b32 s89, s13, 1
    s_lshl_b32 s89, s89, 6
    s_mul_i32 s10, s6, 11
    s_add_u32 s10, s10, s7
    s_lshl_b32 s10, s10, 3
    s_add_u32 s10, s10, s3
    s_add_u32 s10, s10, 1408
    s_min_u32 s10, s10, 1599
    s_mul_hi_u32 s11, s10, 21474837
    s_mul_i32 s12, s11, 200
    s_sub_u32 s12, s10, s12
    s_mul_hi_u32 s13, s12, 858993460
    s_mul_i32 s15, s13, 5
    s_sub_u32 s15, s12, s15
    s_and_b32 s14, s13, 1
    s_mul_i32 s9, s11, 94
    s_add_u32 s9, s9, s13
    s_mul_i32 s9, s9, 5
    s_add_u32 s9, s9, s15
    s_lshl_b32 s9, s9, 10
    s_mul_i32 s11, s11, 80
    s_lshl_b32 s15, s15, 4
    s_add_u32 s15, s15, s11
    v_lshrrev_b32 v3, 2, v2
    v_add_u32 v3, s15, v3
    v_mul_u32_u24 v3, 1280, v3
    v_and_b32 v4, 3, v2
    v_lshl_add_u32 v244, v4, 4, v3
    s_lshr_b32 s8, s13, 1
    s_lshl_b32 s8, s8, 6
    s_mul_i32 s11, s6, 11
    s_add_u32 s11, s11, s7
    s_lshl_b32 s11, s11, 1
    s_add_u32 s11, s11, s3
    s_sub_u32 s11, s11, 1
    s_mul_hi_u32 s13, s11, 79536432
    s_mul_i32 s12, s13, 54
    s_sub_u32 s12, s11, s12
    s_mul_i32 s90, s12, 40960
    s_mul_i32 s15, s13, 160
    s_add_u32 s90, s90, s15
    s_mul_i32 s101, s13, 94
    s_add_u32 s101, s101, s12
    s_add_u32 s101, s101, 40
    s_mul_i32 s101, s101, 5120
    v_add_u32 v3, 0, v2
    s_mov_b32 s15, 429496730
    v_mul_hi_u32 v4, v3, s15
    v_mul_u32_u24 v5, 10, v4
    v_sub_u32 v5, v3, v5
    v_mul_u32_u24 v4, 1280, v4
    v_lshl_add_u32 v233, v5, 4, v4
    v_add_u32 v3, 64, v2
    s_mov_b32 s15, 429496730
    v_mul_hi_u32 v4, v3, s15
    v_mul_u32_u24 v5, 10, v4
    v_sub_u32 v5, v3, v5
    v_mul_u32_u24 v4, 1280, v4
    v_lshl_add_u32 v234, v5, 4, v4
    v_add_u32 v3, 128, v2
    s_mov_b32 s15, 429496730
    v_mul_hi_u32 v4, v3, s15
    v_mul_u32_u24 v5, 10, v4
    v_sub_u32 v5, v3, v5
    v_mul_u32_u24 v4, 1280, v4
    v_lshl_add_u32 v235, v5, 4, v4
    v_add_u32 v3, 192, v2
    s_mov_b32 s15, 429496730
    v_mul_hi_u32 v4, v3, s15
    v_mul_u32_u24 v5, 10, v4
    v_sub_u32 v5, v3, v5
    v_mul_u32_u24 v4, 1280, v4
    v_lshl_add_u32 v236, v5, 4, v4
    v_add_u32 v3, 256, v2
    s_mov_b32 s15, 429496730
    v_mul_hi_u32 v4, v3, s15
    v_mul_u32_u24 v5, 10, v4
    v_sub_u32 v5, v3, v5
    v_mul_u32_u24 v4, 1280, v4
    v_lshl_add_u32 v237, v5, 4, v4
    s_cmp_lt_u32 s3, 6
    s_cbranch_scc1 K1_SJ_F
    s_waitcnt vmcnt(6)
    v_mov_b32 v19, 0
    v_mov_b32 v20, 0
    v_mov_b32 v21, 0
    v_mov_b32 v22, 0
    v_dot2c_f32_bf16 v19, v208, v18
    v_dot2c_f32_bf16 v21, v208, v208
    v_dot2c_f32_bf16 v20, v209, v18
    v_dot2c_f32_bf16 v22, v209, v209
    v_dot2c_f32_bf16 v19, v210, v18
    v_dot2c_f32_bf16 v21, v210, v210
    v_dot2c_f32_bf16 v20, v211, v18
    v_dot2c_f32_bf16 v22, v211, v211
    v_dot2c_f32_bf16 v19, v212, v18
    v_dot2c_f32_bf16 v21, v212, v212
    v_dot2c_f32_bf16 v20, v213, v18
    v_dot2c_f32_bf16 v22, v213, v213
    v_dot2c_f32_bf16 v19, v214, v18
    v_dot2c_f32_bf16 v21, v214, v214
    v_dot2c_f32_bf16 v20, v215, v18
    v_dot2c_f32_bf16 v22, v215, v215
    v_dot2c_f32_bf16 v19, v216, v18
    v_dot2c_f32_bf16 v21, v216, v216
    v_dot2c_f32_bf16 v20, v217, v18
    v_dot2c_f32_bf16 v22, v217, v217
    v_dot2c_f32_bf16 v19, v218, v18
    v_dot2c_f32_bf16 v21, v218, v218
    v_dot2c_f32_bf16 v20, v219, v18
    v_dot2c_f32_bf16 v22, v219, v219
    v_dot2c_f32_bf16 v19, v220, v18
    v_dot2c_f32_bf16 v21, v220, v220
    v_dot2c_f32_bf16 v20, v221, v18
    v_dot2c_f32_bf16 v22, v221, v221
    v_dot2c_f32_bf16 v19, v222, v18
    v_dot2c_f32_bf16 v21, v222, v222
    v_dot2c_f32_bf16 v20, v223, v18
    v_dot2c_f32_bf16 v22, v223, v223
    v_dot2c_f32_bf16 v19, v224, v18
    v_dot2c_f32_bf16 v21, v224, v224
    v_dot2c_f32_bf16 v20, v225, v18
    v_dot2c_f32_bf16 v22, v225, v225
    v_dot2c_f32_bf16 v19, v226, v18
    v_dot2c_f32_bf16 v21, v226, v226
    v_dot2c_f32_bf16 v20, v227, v18
    v_dot2c_f32_bf16 v22, v227, v227
    s_nop 2
    v_add_f32 v19, v19, v20
    v_add_f32 v20, v21, v22
    s_nop 1
    v_add_f32_dpp v19, v19, v19 row_ror:8 row_mask:0xf bank_mask:0xf
    v_add_f32_dpp v20, v20, v20 row_ror:8 row_mask:0xf bank_mask:0xf
    s_nop 1
    v_add_f32_dpp v19, v19, v19 row_ror:4 row_mask:0xf bank_mask:0xf
    v_add_f32_dpp v20, v20, v20 row_ror:4 row_mask:0xf bank_mask:0xf
    s_nop 1
    v_add_f32_dpp v19, v19, v19 row_ror:2 row_mask:0xf bank_mask:0xf
    v_add_f32_dpp v20, v20, v20 row_ror:2 row_mask:0xf bank_mask:0xf
    s_nop 1
    v_add_f32_dpp v19, v19, v19 row_ror:1 row_mask:0xf bank_mask:0xf
    v_add_f32_dpp v20, v20, v20 row_ror:1 row_mask:0xf bank_mask:0xf
    v_mul_f32 v19, 0x3acccccd, v19
    v_mul_f32 v20, 0x3acccccd, v20
    v_fma_f32 v20, -v19, v19, v20
    v_max_f32 v20, 0, v20
    v_cvt_pk_bf16_f32 v21, v19, v20
    v_lshlrev_b32 v238, 16, v21
    v_and_b32 v21, 0xffff0000, v21
    v_add_f32 v21, 0x3727c5ac, v21
    v_cvt_pk_bf16_f32 v21, v21, v21
    v_and_b32 v21, 0xffff0000, v21
    v_sqrt_f32 v21, v21
    s_nop 0
    v_cvt_pk_bf16_f32 v21, v21, v21
    v_and_b32 v21, 0xffff0000, v21
    v_rcp_f32 v239, v21
K1_SJ_F:
    v_mov_b32 v21, 0
    v_mov_b32 v22, 0
    v_mov_b32 v23, 0
    v_mov_b32 v24, 0
    v_mov_b32 v25, 0
    s_cmp_lt_u32 s3, 4
    s_cbranch_scc1 K1F_P1
    s_waitcnt vmcnt(2)
K1F_P1:
    s_waitcnt vmcnt(3)
    s_barrier
    s_mov_b32 s76, 49152
    s_mov_b32 s78, 0
    v_add_u32 v15, s78, v13
    v_xor_b32 v16, 32, v15
    v_add_u32 v17, s76, v14
    s_add_u32 s76, s76, 20544
    s_cmp_ge_u32 s76, 151872
    s_cselect_b32 s76, 49152, s76
    ds_read_b128 v[32:35], v15
    ds_read_b128 v[36:39], v16
    ds_read_b64_tr_b16 v[40:41], v17 offset:0
    ds_read_b64_tr_b16 v[42:43], v17 offset:1280
    ds_read_b64_tr_b16 v[44:45], v17 offset:32
    ds_read_b64_tr_b16 v[46:47], v17 offset:1312
    ds_read_b64_tr_b16 v[48:49], v17 offset:64
    ds_read_b64_tr_b16 v[50:51], v17 offset:1344
    ds_read_b64_tr_b16 v[52:53], v17 offset:96
    ds_read_b64_tr_b16 v[54:55], v17 offset:1376
    ds_read_b64_tr_b16 v[56:57], v17 offset:128
    ds_read_b64_tr_b16 v[58:59], v17 offset:1408
    ds_read_b64_tr_b16 v[60:61], v17 offset:5120
    ds_read_b64_tr_b16 v[62:63], v17 offset:6400
    ds_read_b64_tr_b16 v[64:65], v17 offset:5152
    ds_read_b64_tr_b16 v[66:67], v17 offset:6432
    ds_read_b64_tr_b16 v[68:69], v17 offset:5184
    ds_read_b64_tr_b16 v[70:71], v17 offset:6464
    ds_read_b64_tr_b16 v[72:73], v17 offset:5216
    ds_read_b64_tr_b16 v[74:75], v17 offset:6496
    ds_read_b64_tr_b16 v[76:77], v17 offset:5248
    ds_read_b64_tr_b16 v[78:79], v17 offset:6528
    s_add_u32 m0, s79, s69
    s_nop 0
    buffer_load_dwordx4 v8, s[48:51], s74 offen lds
    s_add_u32 m0, m0, 1024
    s_nop 0
    buffer_load_dwordx4 v9, s[48:51], s74 offen lds
    s_add_u32 s74, s74, 128
    s_cmp_ge_u32 s74, 1280
    s_cselect_b32 s74, 0, s74
    s_add_u32 s79, s79, 16384
    s_cmp_ge_u32 s79, 49152
    s_cselect_b32 s79, 0, s79
    v_mov_b32 v3, 0
    global_load_dword v247, v3, s[44:45] sc1
    s_add_u32 m0, s75, s70
    s_nop 0
    buffer_load_dwordx4 v10, s[52:55], s73 offen lds
    s_add_u32 m0, s75, s71
    s_nop 0
    buffer_load_dwordx4 v11, s[56:59], s73 offen lds
    s_cmp_lt_u32 s3, 4
    s_cbranch_scc0 K1F3_3
    s_add_u32 m0, s75, s72
    s_nop 0
    buffer_load_dwordx4 v12, s[60:63], s73 offen lds
K1F3_3:
    s_add_u32 s73, s73, 110592
    s_sub_u32 s12, s73, 2211840
    s_cmp_ge_u32 s73, s1
    s_cselect_b32 s73, s12, s73
    s_add_u32 s75, s75, 20544
    s_cmp_ge_u32 s75, 151872
    s_cselect_b32 s75, 49152, s75
    s_add_u32 m0, s75, s70
    s_nop 0
    buffer_load_dwordx4 v10, s[52:55], s73 offen lds
    s_add_u32 m0, s75, s71
    s_nop 0
    buffer_load_dwordx4 v11, s[56:59], s73 offen lds
    s_cmp_lt_u32 s3, 4
    s_cbranch_scc0 K1F3_4
    s_add_u32 m0, s75, s72
    s_nop 0
    buffer_load_dwordx4 v12, s[60:63], s73 offen lds
K1F3_4:
    s_add_u32 s73, s73, 110592
    s_sub_u32 s12, s73, 2211840
    s_cmp_ge_u32 s73, s1
    s_cselect_b32 s73, s12, s73
    s_add_u32 s75, s75, 20544
    s_cmp_ge_u32 s75, 151872
    s_cselect_b32 s75, 49152, s75
    s_add_u32 m0, s79, s69
    s_nop 0
    buffer_load_dwordx4 v8, s[48:51], s74 offen lds
    s_add_u32 m0, m0, 1024
    s_nop 0
    buffer_load_dwordx4 v9, s[48:51], s74 offen lds
    s_add_u32 s74, s74, 128
    s_cmp_ge_u32 s74, 1280
    s_cselect_b32 s74, 0, s74
    s_add_u32 s79, s79, 16384
    s_cmp_ge_u32 s79, 49152
    s_cselect_b32 s79, 0, s79
    s_add_u32 s80, s46, 31457280
    s_addc_u32 s81, s47, 0
    s_mov_b32 s82, 384000
    s_mov_b32 s83, 0x20000
    s_add_u32 s84, s46, 30408704
    s_addc_u32 s85, s47, 0
    s_mov_b32 s86, 32768
    s_mov_b32 s87, 0x20000
    v_lshlrev_b32 v29, 3, v0
    v_cmp_gt_u32 vcc, 320, v0
    v_mov_b32 v3, 0x7ffffff0
    s_mul_i32 s88, s7, 25600
    v_cndmask_b32 v29, v3, v29, vcc
    s_lshl_b32 s10, s6, 7
    s_lshl_b32 s11, s4, 5
    s_add_u32 s10, s10, s11
    v_and_b32 v3, 31, v2
    v_add_u32 v3, s10, v3
    v_lshlrev_b32 v30, 4, v3
    s_cmp_ge_u32 s3, 4
    s_cbranch_scc1 K1F_B
    s_waitcnt vmcnt(11) lgkmcnt(0)
    s_barrier
    v_mfma_f32_32x32x16_bf16 v[128:143], v[40:43], v[32:35], v[128:143]
    v_add_u32 v15, s78, v13
    v_xor_b32 v15, 64, v15
    v_xor_b32 v16, 32, v15
    v_add_u32 v17, s76, v14
    s_add_u32 s76, s76, 20544
    s_cmp_ge_u32 s76, 151872
    s_cselect_b32 s76, 49152, s76
    s_add_u32 s78, s78, 16384
    s_cmp_ge_u32 s78, 49152
    s_cselect_b32 s78, 0, s78
    v_mfma_f32_32x32x16_bf16 v[144:159], v[44:47], v[32:35], v[144:159]
    ds_read_b128 v[80:83], v15
    ds_read_b128 v[84:87], v16
    ds_read_b64_tr_b16 v[88:89], v17 offset:0
    ds_read_b64_tr_b16 v[90:91], v17 offset:1280
    s_add_u32 m0, s75, s70
    s_nop 0
    buffer_load_dwordx4 v10, s[52:55], s73 offen lds
    v_mfma_f32_32x32x16_bf16 v[160:175], v[48:51], v[32:35], v[160:175]
    ds_read_b64_tr_b16 v[92:93], v17 offset:32
    ds_read_b64_tr_b16 v[94:95], v17 offset:1312
    ds_read_b64_tr_b16 v[96:97], v17 offset:64
    ds_read_b64_tr_b16 v[98:99], v17 offset:1344
    v_mfma_f32_32x32x16_bf16 v[176:191], v[52:55], v[32:35], v[176:191]
    ds_read_b64_tr_b16 v[100:101], v17 offset:96
    ds_read_b64_tr_b16 v[102:103], v17 offset:1376
    ds_read_b64_tr_b16 v[104:105], v17 offset:128
    ds_read_b64_tr_b16 v[106:107], v17 offset:1408
    s_add_u32 m0, s75, s71
    s_nop 0
    buffer_load_dwordx4 v11, s[56:59], s73 offen lds
    v_mfma_f32_32x32x16_bf16 v[192:207], v[56:59], v[32:35], v[192:207]
    ds_read_b64_tr_b16 v[108:109], v17 offset:5120
    ds_read_b64_tr_b16 v[110:111], v17 offset:6400
    ds_read_b64_tr_b16 v[112:113], v17 offset:5152
    ds_read_b64_tr_b16 v[114:115], v17 offset:6432
    v_mfma_f32_32x32x16_bf16 v[128:143], v[60:63], v[36:39], v[128:143]
    ds_read_b64_tr_b16 v[116:117], v17 offset:5184
    ds_read_b64_tr_b16 v[118:119], v17 offset:6464
    ds_read_b64_tr_b16 v[120:121], v17 offset:5216
    ds_read_b64_tr_b16 v[122:123], v17 offset:6496
    s_add_u32 m0, s75, s72
    s_nop 0
    buffer_load_dwordx4 v12, s[60:63], s73 offen lds
    v_mfma_f32_32x32x16_bf16 v[144:159], v[64:67], v[36:39], v[144:159]
    ds_read_b64_tr_b16 v[124:125], v17 offset:5248
    ds_read_b64_tr_b16 v[126:127], v17 offset:6528
    v_mfma_f32_32x32x16_bf16 v[160:175], v[68:71], v[36:39], v[160:175]
    v_mfma_f32_32x32x16_bf16 v[176:191], v[72:75], v[36:39], v[176:191]
    s_add_u32 s73, s73, 110592
    s_sub_u32 s12, s73, 2211840
    s_cmp_ge_u32 s73, s1
    s_cselect_b32 s73, s12, s73
    s_add_u32 s75, s75, 20544
    s_cmp_ge_u32 s75, 151872
    s_cselect_b32 s75, 49152, s75
    s_cmp_eq_u32 s68, 0
    s_cbranch_scc1 K1C_5
    v_dot2c_f32_bf16 v21, v40, v18
    v_dot2c_f32_bf16 v22, v44, v18
    v_dot2c_f32_bf16 v23, v48, v18
    v_dot2c_f32_bf16 v24, v52, v18
    v_dot2c_f32_bf16 v25, v56, v18
    v_dot2c_f32_bf16 v21, v41, v18
    v_dot2c_f32_bf16 v22, v45, v18
    v_dot2c_f32_bf16 v23, v49, v18
    v_dot2c_f32_bf16 v24, v53, v18
    v_dot2c_f32_bf16 v25, v57, v18
    v_dot2c_f32_bf16 v21, v42, v18
    v_dot2c_f32_bf16 v22, v46, v18
    v_dot2c_f32_bf16 v23, v50, v18
    v_dot2c_f32_bf16 v24, v54, v18
    v_dot2c_f32_bf16 v25, v58, v18
    v_dot2c_f32_bf16 v21, v43, v18
    v_dot2c_f32_bf16 v22, v47, v18
    v_dot2c_f32_bf16 v23, v51, v18
    v_dot2c_f32_bf16 v24, v55, v18
    v_dot2c_f32_bf16 v25, v59, v18
    v_dot2c_f32_bf16 v21, v60, v18
    v_dot2c_f32_bf16 v22, v64, v18
    v_dot2c_f32_bf16 v23, v68, v18
    v_dot2c_f32_bf16 v24, v72, v18
    v_dot2c_f32_bf16 v25, v76, v18
    v_dot2c_f32_bf16 v21, v61, v18
    v_dot2c_f32_bf16 v22, v65, v18
    v_dot2c_f32_bf16 v23, v69, v18
    v_dot2c_f32_bf16 v24, v73, v18
    v_dot2c_f32_bf16 v25, v77, v18
    v_dot2c_f32_bf16 v21, v62, v18
    v_dot2c_f32_bf16 v22, v66, v18
    v_dot2c_f32_bf16 v23, v70, v18
    v_dot2c_f32_bf16 v24, v74, v18
    v_dot2c_f32_bf16 v25, v78, v18
    v_dot2c_f32_bf16 v21, v63, v18
    v_dot2c_f32_bf16 v22, v67, v18
    v_dot2c_f32_bf16 v23, v71, v18
    v_dot2c_f32_bf16 v24, v75, v18
    v_dot2c_f32_bf16 v25, v79, v18
K1C_5:
    v_mfma_f32_32x32x16_bf16 v[192:207], v[76:79], v[36:39], v[192:207]
    s_waitcnt vmcnt(3) lgkmcnt(0)
    s_barrier
    v_mfma_f32_32x32x16_bf16 v[128:143], v[88:91], v[80:83], v[128:143]
    v_add_u32 v15, s78, v13
    v_xor_b32 v16, 32, v15
    v_add_u32 v17, s76, v14
    s_add_u32 s76, s76, 20544
    s_cmp_ge_u32 s76, 151872
    s_cselect_b32 s76, 49152, s76
    v_mfma_f32_32x32x16_bf16 v[144:159], v[92:95], v[80:83], v[144:159]
    ds_read_b128 v[32:35], v15
    ds_read_b128 v[36:39], v16
    ds_read_b64_tr_b16 v[40:41], v17 offset:0
    ds_read_b64_tr_b16 v[42:43], v17 offset:1280
    s_add_u32 m0, s75, s70
    s_nop 0
    buffer_load_dwordx4 v10, s[52:55], s73 offen lds
    v_mfma_f32_32x32x16_bf16 v[160:175], v[96:99], v[80:83], v[160:175]
    ds_read_b64_tr_b16 v[44:45], v17 offset:32
    ds_read_b64_tr_b16 v[46:47], v17 offset:1312
    ds_read_b64_tr_b16 v[48:49], v17 offset:64
    ds_read_b64_tr_b16 v[50:51], v17 offset:1344
    v_mfma_f32_32x32x16_bf16 v[176:191], v[100:103], v[80:83], v[176:191]
    ds_read_b64_tr_b16 v[52:53], v17 offset:96
    ds_read_b64_tr_b16 v[54:55], v17 offset:1376
    ds_read_b64_tr_b16 v[56:57], v17 offset:128
    ds_read_b64_tr_b16 v[58:59], v17 offset:1408
    s_add_u32 m0, s75, s71
    s_nop 0
    buffer_load_dwordx4 v11, s[56:59], s73 offen lds
    v_mfma_f32_32x32x16_bf16 v[192:207], v[104:107], v[80:83], v[192:207]
    ds_read_b64_tr_b16 v[60:61], v17 offset:5120
    ds_read_b64_tr_b16 v[62:63], v17 offset:6400
    ds_read_b64_tr_b16 v[64:65], v17 offset:5152
    ds_read_b64_tr_b16 v[66:67], v17 offset:6432
    v_mfma_f32_32x32x16_bf16 v[128:143], v[108:111], v[84:87], v[128:143]
    ds_read_b64_tr_b16 v[68:69], v17 offset:5184
    ds_read_b64_tr_b16 v[70:71], v17 offset:6464
    ds_read_b64_tr_b16 v[72:73], v17 offset:5216
    ds_read_b64_tr_b16 v[74:75], v17 offset:6496
    s_add_u32 m0, s75, s72
    s_nop 0
    buffer_load_dwordx4 v12, s[60:63], s73 offen lds
    v_mfma_f32_32x32x16_bf16 v[144:159], v[112:115], v[84:87], v[144:159]
    ds_read_b64_tr_b16 v[76:77], v17 offset:5248
    ds_read_b64_tr_b16 v[78:79], v17 offset:6528
    s_add_u32 m0, s79, s69
    s_nop 0
    buffer_load_dwordx4 v8, s[48:51], s74 offen lds
    v_mfma_f32_32x32x16_bf16 v[160:175], v[116:119], v[84:87], v[160:175]
    s_add_u32 m0, s79, s69
    s_add_u32 m0, m0, 1024
    s_nop 0
    buffer_load_dwordx4 v9, s[48:51], s74 offen lds
    v_mfma_f32_32x32x16_bf16 v[176:191], v[120:123], v[84:87], v[176:191]
    s_add_u32 s73, s73, 110592
    s_sub_u32 s12, s73, 2211840
    s_cmp_ge_u32 s73, s1
    s_cselect_b32 s73, s12, s73
    s_add_u32 s75, s75, 20544
    s_cmp_ge_u32 s75, 151872
    s_cselect_b32 s75, 49152, s75
    s_add_u32 s74, s74, 128
    s_cmp_ge_u32 s74, 1280
    s_cselect_b32 s74, 0, s74
    s_add_u32 s79, s79, 16384
    s_cmp_ge_u32 s79, 49152
    s_cselect_b32 s79, 0, s79
    s_cmp_eq_u32 s68, 0
    s_cbranch_scc1 K1C_6
    v_dot2c_f32_bf16 v21, v88, v18
    v_dot2c_f32_bf16 v22, v92, v18
    v_dot2c_f32_bf16 v23, v96, v18
    v_dot2c_f32_bf16 v24, v100, v18
    v_dot2c_f32_bf16 v25, v104, v18
    v_dot2c_f32_bf16 v21, v89, v18
    v_dot2c_f32_bf16 v22, v93, v18
    v_dot2c_f32_bf16 v23, v97, v18
    v_dot2c_f32_bf16 v24, v101, v18
    v_dot2c_f32_bf16 v25, v105, v18
    v_dot2c_f32_bf16 v21, v90, v18
    v_dot2c_f32_bf16 v22, v94, v18
    v_dot2c_f32_bf16 v23, v98, v18
    v_dot2c_f32_bf16 v24, v102, v18
    v_dot2c_f32_bf16 v25, v106, v18
    v_dot2c_f32_bf16 v21, v91, v18
    v_dot2c_f32_bf16 v22, v95, v18
    v_dot2c_f32_bf16 v23, v99, v18
    v_dot2c_f32_bf16 v24, v103, v18
    v_dot2c_f32_bf16 v25, v107, v18
    v_dot2c_f32_bf16 v21, v108, v18
    v_dot2c_f32_bf16 v22, v112, v18
    v_dot2c_f32_bf16 v23, v116, v18
    v_dot2c_f32_bf16 v24, v120, v18
    v_dot2c_f32_bf16 v25, v124, v18
    v_dot2c_f32_bf16 v21, v109, v18
    v_dot2c_f32_bf16 v22, v113, v18
    v_dot2c_f32_bf16 v23, v117, v18
    v_dot2c_f32_bf16 v24, v121, v18
    v_dot2c_f32_bf16 v25, v125, v18
    v_dot2c_f32_bf16 v21, v110, v18
    v_dot2c_f32_bf16 v22, v114, v18
    v_dot2c_f32_bf16 v23, v118, v18
    v_dot2c_f32_bf16 v24, v122, v18
    v_dot2c_f32_bf16 v25, v126, v18
    v_dot2c_f32_bf16 v21, v111, v18
    v_dot2c_f32_bf16 v22, v115, v18
    v_dot2c_f32_bf16 v23, v119, v18
    v_dot2c_f32_bf16 v24, v123, v18
    v_dot2c_f32_bf16 v25, v127, v18
    v_mov_b32 v208, v21
    v_mov_b32 v210, v22
    v_mov_b32 v212, v23
    v_mov_b32 v214, v24
    v_mov_b32 v216, v25
    s_nop 1
    v_permlane32_swap_b32 v21, v208
    v_permlane32_swap_b32 v22, v210
    v_permlane32_swap_b32 v23, v212
    v_permlane32_swap_b32 v24, v214
    v_permlane32_swap_b32 v25, v216
    v_add_f32 v208, v21, v208
    v_add_f32 v210, v22, v210
    v_add_f32 v212, v23, v212
    v_add_f32 v214, v24, v214
    v_add_f32 v216, v25, v216
    v_readfirstlane_b32 s10, v247
    s_cmp_lg_u32 s10, 0
    s_cbranch_scc1 K1_EN1_FCA
    v_mov_b32 v3, 0
    s_mov_b32 s11, 30000
K1_EN0_FCA:
    global_load_dword v247, v3, s[44:45] sc1
    s_waitcnt vmcnt(0)
    v_readfirstlane_b32 s10, v247
    s_sub_u32 s11, s11, 1
    s_cmp_eq_u32 s11, 0
    s_cbranch_scc1 K1_EN1_FCA
    s_cmp_eq_u32 s10, 0
    s_cbranch_scc1 K1_EN0_FCA
K1_EN1_FCA:
    v_mov_b32 v209, v247
    v_mov_b32 v211, v247
    v_mov_b32 v213, v247
    v_mov_b32 v215, v247
    v_mov_b32 v217, v247
    v_and_b32 v3, 31, v2
    s_mul_i32 s10, s5, 160
    v_add_u32 v3, s10, v3
    v_lshlrev_b32 v3, 3, v3
    s_mul_i32 s10, s0, 2560
    s_add_u32 s10, s10, s88
    s_mov_b32 exec_hi, 0
    buffer_store_dwordx2 v[208:209], v3, s[80:83], s10 offen offset:0 sc1
    buffer_store_dwordx2 v[210:211], v3, s[80:83], s10 offen offset:256 sc1
    buffer_store_dwordx2 v[212:213], v3, s[80:83], s10 offen offset:512 sc1
    buffer_store_dwordx2 v[214:215], v3, s[80:83], s10 offen offset:768 sc1
    buffer_store_dwordx2 v[216:217], v3, s[80:83], s10 offen offset:1024 sc1
    s_mov_b32 exec_hi, -1
K1C_6:
    s_mov_b32 s77, 1
    s_cmp_lt_u32 s3, 6
    s_cbranch_scc1 K1_SP_FA
    s_cmp_eq_u32 s77, 1
    s_cbranch_scc0 K1_SP_FA
    v_readfirstlane_b32 s10, v247
    s_cmp_lg_u32 s10, 0
    s_cbranch_scc1 K1_EN1_FAP
    v_mov_b32 v3, 0
    s_mov_b32 s11, 30000
K1_EN0_FAP:
    global_load_dword v247, v3, s[44:45] sc1
    s_waitcnt vmcnt(0)
    v_readfirstlane_b32 s10, v247
    s_sub_u32 s11, s11, 1
    s_cmp_eq_u32 s11, 0
    s_cbranch_scc1 K1_EN1_FAP
    s_cmp_eq_u32 s10, 0
    s_cbranch_scc1 K1_EN0_FAP
K1_EN1_FAP:
    v_mov_b32 v240, v238
    v_mov_b32 v241, v239
    v_mov_b32 v242, v247
    v_not_b32 v243, v247
    v_lshlrev_b32 v3, 4, v28
    v_and_b32 v4, 15, v2
    v_cmp_eq_u32 vcc, 0, v4
    s_and_saveexec_b64 s[10:11], vcc
    buffer_store_dwordx4 v[240:243], v3, s[84:87], 0 offen sc1
    s_mov_b64 exec, s[10:11]
K1_SP_FA:
    v_mfma_f32_32x32x16_bf16 v[192:207], v[124:127], v[84:87], v[192:207]
    s_mov_b32 s77, 6
K1F_LOOP_A:
    s_waitcnt lgkmcnt(0)
    v_mfma_f32_32x32x16_bf16 v[128:143], v[40:43], v[32:35], v[128:143]
    v_add_u32 v15, s78, v13
    v_xor_b32 v15, 64, v15
    v_xor_b32 v16, 32, v15
    v_add_u32 v17, s76, v14
    s_add_u32 s76, s76, 20544
    s_cmp_ge_u32 s76, 151872
    s_cselect_b32 s76, 49152, s76
    s_add_u32 s78, s78, 16384
    s_cmp_ge_u32 s78, 49152
    s_cselect_b32 s78, 0, s78
    v_mfma_f32_32x32x16_bf16 v[144:159], v[44:47], v[32:35], v[144:159]
    ds_read_b128 v[80:83], v15
    ds_read_b128 v[84:87], v16
    ds_read_b64_tr_b16 v[88:89], v17 offset:0
    ds_read_b64_tr_b16 v[90:91], v17 offset:1280
    s_add_u32 m0, s75, s70
    s_nop 0
    buffer_load_dwordx4 v10, s[52:55], s73 offen lds
    v_mfma_f32_32x32x16_bf16 v[160:175], v[48:51], v[32:35], v[160:175]
    ds_read_b64_tr_b16 v[92:93], v17 offset:32
    ds_read_b64_tr_b16 v[94:95], v17 offset:1312
    ds_read_b64_tr_b16 v[96:97], v17 offset:64
    ds_read_b64_tr_b16 v[98:99], v17 offset:1344
    v_mfma_f32_32x32x16_bf16 v[176:191], v[52:55], v[32:35], v[176:191]
    ds_read_b64_tr_b16 v[100:101], v17 offset:96
    ds_read_b64_tr_b16 v[102:103], v17 offset:1376
    ds_read_b64_tr_b16 v[104:105], v17 offset:128
    ds_read_b64_tr_b16 v[106:107], v17 offset:1408
    s_add_u32 m0, s75, s71
    s_nop 0
    buffer_load_dwordx4 v11, s[56:59], s73 offen lds
    v_mfma_f32_32x32x16_bf16 v[192:207], v[56:59], v[32:35], v[192:207]
    ds_read_b64_tr_b16 v[108:109], v17 offset:5120
    ds_read_b64_tr_b16 v[110:111], v17 offset:6400
    ds_read_b64_tr_b16 v[112:113], v17 offset:5152
    ds_read_b64_tr_b16 v[114:115], v17 offset:6432
    v_mfma_f32_32x32x16_bf16 v[128:143], v[60:63], v[36:39], v[128:143]
    ds_read_b64_tr_b16 v[116:117], v17 offset:5184
    ds_read_b64_tr_b16 v[118:119], v17 offset:6464
    ds_read_b64_tr_b16 v[120:121], v17 offset:5216
    ds_read_b64_tr_b16 v[122:123], v17 offset:6496
    s_add_u32 m0, s75, s72
    s_nop 0
    buffer_load_dwordx4 v12, s[60:63], s73 offen lds
    v_mfma_f32_32x32x16_bf16 v[144:159], v[64:67], v[36:39], v[144:159]
    ds_read_b64_tr_b16 v[124:125], v17 offset:5248
    ds_read_b64_tr_b16 v[126:127], v17 offset:6528
    v_mfma_f32_32x32x16_bf16 v[160:175], v[68:71], v[36:39], v[160:175]
    v_mfma_f32_32x32x16_bf16 v[176:191], v[72:75], v[36:39], v[176:191]
    s_add_u32 s73, s73, 110592
    s_sub_u32 s12, s73, 2211840
    s_cmp_ge_u32 s73, s1
    s_cselect_b32 s73, s12, s73
    s_add_u32 s75, s75, 20544
    s_cmp_ge_u32 s75, 151872
    s_cselect_b32 s75, 49152, s75
    v_mfma_f32_32x32x16_bf16 v[192:207], v[76:79], v[36:39], v[192:207]
    s_waitcnt vmcnt(3) lgkmcnt(0)
    s_barrier
    v_mfma_f32_32x32x16_bf16 v[128:143], v[88:91], v[80:83], v[128:143]
    v_add_u32 v15, s78, v13
    v_xor_b32 v16, 32, v15
    v_add_u32 v17, s76, v14
    s_add_u32 s76, s76, 20544
    s_cmp_ge_u32 s76, 151872
    s_cselect_b32 s76, 49152, s76
    v_mfma_f32_32x32x16_bf16 v[144:159], v[92:95], v[80:83], v[144:159]
    ds_read_b128 v[32:35], v15
    ds_read_b128 v[36:39], v16
    ds_read_b64_tr_b16 v[40:41], v17 offset:0
    ds_read_b64_tr_b16 v[42:43], v17 offset:1280
    s_add_u32 m0, s75, s70
    s_nop 0
    buffer_load_dwordx4 v10, s[52:55], s73 offen lds
    v_mfma_f32_32x32x16_bf16 v[160:175], v[96:99], v[80:83], v[160:175]
    ds_read_b64_tr_b16 v[44:45], v17 offset:32
    ds_read_b64_tr_b16 v[46:47], v17 offset:1312
    ds_read_b64_tr_b16 v[48:49], v17 offset:64
    ds_read_b64_tr_b16 v[50:51], v17 offset:1344
    v_mfma_f32_32x32x16_bf16 v[176:191], v[100:103], v[80:83], v[176:191]
    ds_read_b64_tr_b16 v[52:53], v17 offset:96
    ds_read_b64_tr_b16 v[54:55], v17 offset:1376
    ds_read_b64_tr_b16 v[56:57], v17 offset:128
    ds_read_b64_tr_b16 v[58:59], v17 offset:1408
    s_add_u32 m0, s75, s71
    s_nop 0
    buffer_load_dwordx4 v11, s[56:59], s73 offen lds
    v_mfma_f32_32x32x16_bf16 v[192:207], v[104:107], v[80:83], v[192:207]
    ds_read_b64_tr_b16 v[60:61], v17 offset:5120
    ds_read_b64_tr_b16 v[62:63], v17 offset:6400
    ds_read_b64_tr_b16 v[64:65], v17 offset:5152
    ds_read_b64_tr_b16 v[66:67], v17 offset:6432
    v_mfma_f32_32x32x16_bf16 v[128:143], v[108:111], v[84:87], v[128:143]
    ds_read_b64_tr_b16 v[68:69], v17 offset:5184
    ds_read_b64_tr_b16 v[70:71], v17 offset:6464
    ds_read_b64_tr_b16 v[72:73], v17 offset:5216
    ds_read_b64_tr_b16 v[74:75], v17 offset:6496
    s_add_u32 m0, s75, s72
    s_nop 0
    buffer_load_dwordx4 v12, s[60:63], s73 offen lds
    v_mfma_f32_32x32x16_bf16 v[144:159], v[112:115], v[84:87], v[144:159]
    ds_read_b64_tr_b16 v[76:77], v17 offset:5248
    ds_read_b64_tr_b16 v[78:79], v17 offset:6528
    s_add_u32 m0, s79, s69
    s_nop 0
    buffer_load_dwordx4 v8, s[48:51], s74 offen lds
    v_mfma_f32_32x32x16_bf16 v[160:175], v[116:119], v[84:87], v[160:175]
    s_add_u32 m0, s79, s69
    s_add_u32 m0, m0, 1024
    s_nop 0
    buffer_load_dwordx4 v9, s[48:51], s74 offen lds
    v_mfma_f32_32x32x16_bf16 v[176:191], v[120:123], v[84:87], v[176:191]
    s_add_u32 s73, s73, 110592
    s_sub_u32 s12, s73, 2211840
    s_cmp_ge_u32 s73, s1
    s_cselect_b32 s73, s12, s73
    s_add_u32 s75, s75, 20544
    s_cmp_ge_u32 s75, 151872
    s_cselect_b32 s75, 49152, s75
    s_add_u32 s74, s74, 128
    s_cmp_ge_u32 s74, 1280
    s_cselect_b32 s74, 0, s74
    s_add_u32 s79, s79, 16384
    s_cmp_ge_u32 s79, 49152
    s_cselect_b32 s79, 0, s79
    s_cmp_eq_u32 s77, 6
    s_cbranch_scc1 HK_FA_I
HK_FA_I_B:
    s_cmp_eq_u32 s77, 4
    s_cbranch_scc1 HK_FA_F
HK_FA_F_B:
    s_cmp_eq_u32 s77, 2
    s_cbranch_scc1 HK_FA_A
HK_FA_A_B:
    v_mfma_f32_32x32x16_bf16 v[192:207], v[124:127], v[84:87], v[192:207]
    s_sub_u32 s77, s77, 1
    s_cmp_lg_u32 s77, 0
    s_cbranch_scc1 K1F_LOOP_A
    s_waitcnt lgkmcnt(0)
    v_mfma_f32_32x32x16_bf16 v[128:143], v[40:43], v[32:35], v[128:143]
    v_add_u32 v15, s78, v13
    v_xor_b32 v15, 64, v15
    v_xor_b32 v16, 32, v15
    v_add_u32 v17, s76, v14
    s_add_u32 s76, s76, 20544
    s_cmp_ge_u32 s76, 151872
    s_cselect_b32 s76, 49152, s76
    s_add_u32 s78, s78, 16384
    s_cmp_ge_u32 s78, 49152
    s_cselect_b32 s78, 0, s78
    v_mfma_f32_32x32x16_bf16 v[144:159], v[44:47], v[32:35], v[144:159]
    ds_read_b128 v[80:83], v15
    ds_read_b128 v[84:87], v16
    ds_read_b64_tr_b16 v[88:89], v17 offset:0
    ds_read_b64_tr_b16 v[90:91], v17 offset:1280
    s_add_u32 m0, s75, s70
    s_nop 0
    buffer_load_dwordx4 v10, s[52:55], s73 offen lds
    v_mfma_f32_32x32x16_bf16 v[160:175], v[48:51], v[32:35], v[160:175]
    ds_read_b64_tr_b16 v[92:93], v17 offset:32
    ds_read_b64_tr_b16 v[94:95], v17 offset:1312
    ds_read_b64_tr_b16 v[96:97], v17 offset:64
    ds_read_b64_tr_b16 v[98:99], v17 offset:1344
    v_mfma_f32_32x32x16_bf16 v[176:191], v[52:55], v[32:35], v[176:191]
    ds_read_b64_tr_b16 v[100:101], v17 offset:96
    ds_read_b64_tr_b16 v[102:103], v17 offset:1376
    ds_read_b64_tr_b16 v[104:105], v17 offset:128
    ds_read_b64_tr_b16 v[106:107], v17 offset:1408
    s_add_u32 m0, s75, s71
    s_nop 0
    buffer_load_dwordx4 v11, s[56:59], s73 offen lds
    v_mfma_f32_32x32x16_bf16 v[192:207], v[56:59], v[32:35], v[192:207]
    ds_read_b64_tr_b16 v[108:109], v17 offset:5120
    ds_read_b64_tr_b16 v[110:111], v17 offset:6400
    ds_read_b64_tr_b16 v[112:113], v17 offset:5152
    ds_read_b64_tr_b16 v[114:115], v17 offset:6432
    v_mfma_f32_32x32x16_bf16 v[128:143], v[60:63], v[36:39], v[128:143]
    ds_read_b64_tr_b16 v[116:117], v17 offset:5184
    ds_read_b64_tr_b16 v[118:119], v17 offset:6464
    ds_read_b64_tr_b16 v[120:121], v17 offset:5216
    ds_read_b64_tr_b16 v[122:123], v17 offset:6496
    s_add_u32 m0, s75, s72
    s_nop 0
    buffer_load_dwordx4 v12, s[60:63], s73 offen lds
    v_mfma_f32_32x32x16_bf16 v[144:159], v[64:67], v[36:39], v[144:159]
    ds_read_b64_tr_b16 v[124:125], v17 offset:5248
    ds_read_b64_tr_b16 v[126:127], v17 offset:6528
    v_mfma_f32_32x32x16_bf16 v[160:175], v[68:71], v[36:39], v[160:175]
    v_mfma_f32_32x32x16_bf16 v[176:191], v[72:75], v[36:39], v[176:191]
    s_add_u32 s73, s73, 110592
    s_sub_u32 s12, s73, 2211840
    s_cmp_ge_u32 s73, s1
    s_cselect_b32 s73, s12, s73
    s_add_u32 s75, s75, 20544
    s_cmp_ge_u32 s75, 151872
    s_cselect_b32 s75, 49152, s75
    s_cmp_eq_u32 s3, 0
    s_cbranch_scc0 K1_AC_CBFA
    v_readfirstlane_b32 s10, v31
    s_cmp_eq_u32 s10, 255
    s_cbranch_scc0 K1_AC_CBFA
    v_readfirstlane_b32 s10, v247
    s_cmp_lg_u32 s10, 0
    s_cbranch_scc1 K1_EN1_ACCBFA
    v_mov_b32 v3, 0
    s_mov_b32 s11, 30000
K1_EN0_ACCBFA:
    global_load_dword v247, v3, s[44:45] sc1
    s_waitcnt vmcnt(0)
    v_readfirstlane_b32 s10, v247
    s_sub_u32 s11, s11, 1
    s_cmp_eq_u32 s11, 0
    s_cbranch_scc1 K1_EN1_ACCBFA
    s_cmp_eq_u32 s10, 0
    s_cbranch_scc1 K1_EN0_ACCBFA
K1_EN1_ACCBFA:
    s_mov_b32 s11, 32505856
    v_lshlrev_b32 v27, 7, v2
    v_add_u32 v27, s11, v27
    s_mov_b32 exec_hi, 0
    global_store_dword v27, v247, s[46:47] sc1
    s_mov_b64 exec, -1
K1_AC_CBFA:
    v_mfma_f32_32x32x16_bf16 v[192:207], v[76:79], v[36:39], v[192:207]
    s_waitcnt vmcnt(3) lgkmcnt(0)
    s_barrier
    v_mfma_f32_32x32x16_bf16 v[128:143], v[88:91], v[80:83], v[128:143]
    v_add_u32 v15, s78, v13
    v_xor_b32 v16, 32, v15
    v_add_u32 v17, s76, v14
    s_add_u32 s76, s76, 20544
    s_cmp_ge_u32 s76, 151872
    s_cselect_b32 s76, 49152, s76
    v_mfma_f32_32x32x16_bf16 v[144:159], v[92:95], v[80:83], v[144:159]
    ds_read_b128 v[32:35], v15
    ds_read_b128 v[36:39], v16
    ds_read_b64_tr_b16 v[40:41], v17 offset:0
    ds_read_b64_tr_b16 v[42:43], v17 offset:1280
    s_add_u32 m0, s75, s70
    s_nop 0
    buffer_load_dwordx4 v10, s[52:55], s73 offen lds
    v_mfma_f32_32x32x16_bf16 v[160:175], v[96:99], v[80:83], v[160:175]
    ds_read_b64_tr_b16 v[44:45], v17 offset:32
    ds_read_b64_tr_b16 v[46:47], v17 offset:1312
    ds_read_b64_tr_b16 v[48:49], v17 offset:64
    ds_read_b64_tr_b16 v[50:51], v17 offset:1344
    v_mfma_f32_32x32x16_bf16 v[176:191], v[100:103], v[80:83], v[176:191]
    ds_read_b64_tr_b16 v[52:53], v17 offset:96
    ds_read_b64_tr_b16 v[54:55], v17 offset:1376
    ds_read_b64_tr_b16 v[56:57], v17 offset:128
    ds_read_b64_tr_b16 v[58:59], v17 offset:1408
    s_add_u32 m0, s75, s71
    s_nop 0
    buffer_load_dwordx4 v11, s[56:59], s73 offen lds
    v_mfma_f32_32x32x16_bf16 v[192:207], v[104:107], v[80:83], v[192:207]
    ds_read_b64_tr_b16 v[60:61], v17 offset:5120
    ds_read_b64_tr_b16 v[62:63], v17 offset:6400
    ds_read_b64_tr_b16 v[64:65], v17 offset:5152
    ds_read_b64_tr_b16 v[66:67], v17 offset:6432
    v_mfma_f32_32x32x16_bf16 v[128:143], v[108:111], v[84:87], v[128:143]
    ds_read_b64_tr_b16 v[68:69], v17 offset:5184
    ds_read_b64_tr_b16 v[70:71], v17 offset:6464
    ds_read_b64_tr_b16 v[72:73], v17 offset:5216
    ds_read_b64_tr_b16 v[74:75], v17 offset:6496
    s_add_u32 m0, s75, s72
    s_nop 0
    buffer_load_dwordx4 v12, s[60:63], s73 offen lds
    v_mfma_f32_32x32x16_bf16 v[144:159], v[112:115], v[84:87], v[144:159]
    ds_read_b64_tr_b16 v[76:77], v17 offset:5248
    ds_read_b64_tr_b16 v[78:79], v17 offset:6528
    v_mfma_f32_32x32x16_bf16 v[160:175], v[116:119], v[84:87], v[160:175]
    v_mfma_f32_32x32x16_bf16 v[176:191], v[120:123], v[84:87], v[176:191]
    s_add_u32 s73, s73, 110592
    s_sub_u32 s12, s73, 2211840
    s_cmp_ge_u32 s73, s1
    s_cselect_b32 s73, s12, s73
    s_add_u32 s75, s75, 20544
    s_cmp_ge_u32 s75, 151872
    s_cselect_b32 s75, 49152, s75
    v_mfma_f32_32x32x16_bf16 v[192:207], v[124:127], v[84:87], v[192:207]
    s_waitcnt lgkmcnt(0)
    v_mfma_f32_32x32x16_bf16 v[128:143], v[40:43], v[32:35], v[128:143]
    v_add_u32 v15, s78, v13
    v_xor_b32 v15, 64, v15
    v_xor_b32 v16, 32, v15
    v_add_u32 v17, s76, v14
    s_add_u32 s76, s76, 20544
    s_cmp_ge_u32 s76, 151872
    s_cselect_b32 s76, 49152, s76
    s_add_u32 s78, s78, 16384
    s_cmp_ge_u32 s78, 49152
    s_cselect_b32 s78, 0, s78
    v_mfma_f32_32x32x16_bf16 v[144:159], v[44:47], v[32:35], v[144:159]
    ds_read_b128 v[80:83], v15
    ds_read_b128 v[84:87], v16
    ds_read_b64_tr_b16 v[88:89], v17 offset:0
    ds_read_b64_tr_b16 v[90:91], v17 offset:1280
    v_mfma_f32_32x32x16_bf16 v[160:175], v[48:51], v[32:35], v[160:175]
    ds_read_b64_tr_b16 v[92:93], v17 offset:32
    ds_read_b64_tr_b16 v[94:95], v17 offset:1312
    ds_read_b64_tr_b16 v[96:97], v17 offset:64
    ds_read_b64_tr_b16 v[98:99], v17 offset:1344
    v_mfma_f32_32x32x16_bf16 v[176:191], v[52:55], v[32:35], v[176:191]
    ds_read_b64_tr_b16 v[100:101], v17 offset:96
    ds_read_b64_tr_b16 v[102:103], v17 offset:1376
    ds_read_b64_tr_b16 v[104:105], v17 offset:128
    ds_read_b64_tr_b16 v[106:107], v17 offset:1408
    v_mfma_f32_32x32x16_bf16 v[192:207], v[56:59], v[32:35], v[192:207]
    ds_read_b64_tr_b16 v[108:109], v17 offset:5120
    ds_read_b64_tr_b16 v[110:111], v17 offset:6400
    ds_read_b64_tr_b16 v[112:113], v17 offset:5152
    ds_read_b64_tr_b16 v[114:115], v17 offset:6432
    v_mfma_f32_32x32x16_bf16 v[128:143], v[60:63], v[36:39], v[128:143]
    ds_read_b64_tr_b16 v[116:117], v17 offset:5184
    ds_read_b64_tr_b16 v[118:119], v17 offset:6464
    ds_read_b64_tr_b16 v[120:121], v17 offset:5216
    ds_read_b64_tr_b16 v[122:123], v17 offset:6496
    v_mfma_f32_32x32x16_bf16 v[144:159], v[64:67], v[36:39], v[144:159]
    ds_read_b64_tr_b16 v[124:125], v17 offset:5248
    ds_read_b64_tr_b16 v[126:127], v17 offset:6528
    v_mfma_f32_32x32x16_bf16 v[160:175], v[68:71], v[36:39], v[160:175]
    v_mfma_f32_32x32x16_bf16 v[176:191], v[72:75], v[36:39], v[176:191]
    s_add_u32 s12, s88, 0
    buffer_load_dwordx2 v[208:209], v29, s[80:83], s12 offen sc1
    s_add_u32 s12, s88, 2560
    buffer_load_dwordx2 v[210:211], v29, s[80:83], s12 offen sc1
    s_add_u32 s12, s88, 5120
    buffer_load_dwordx2 v[212:213], v29, s[80:83], s12 offen sc1
    s_add_u32 s12, s88, 7680
    buffer_load_dwordx2 v[214:215], v29, s[80:83], s12 offen sc1
    s_add_u32 s12, s88, 10240
    buffer_load_dwordx2 v[216:217], v29, s[80:83], s12 offen sc1
    s_add_u32 s12, s88, 12800
    buffer_load_dwordx2 v[218:219], v29, s[80:83], s12 offen sc1
    s_add_u32 s12, s88, 15360
    buffer_load_dwordx2 v[220:221], v29, s[80:83], s12 offen sc1
    s_add_u32 s12, s88, 17920
    buffer_load_dwordx2 v[222:223], v29, s[80:83], s12 offen sc1
    s_add_u32 s12, s88, 20480
    buffer_load_dwordx2 v[224:225], v29, s[80:83], s12 offen sc1
    s_add_u32 s12, s88, 23040
    buffer_load_dwordx2 v[226:227], v29, s[80:83], s12 offen sc1
    buffer_load_dwordx4 v[228:231], v30, s[84:87], 0 offen sc1
    v_mfma_f32_32x32x16_bf16 v[192:207], v[76:79], v[36:39], v[192:207]
    s_waitcnt vmcnt(11) lgkmcnt(0)
    s_barrier
    v_mfma_f32_32x32x16_bf16 v[128:143], v[88:91], v[80:83], v[128:143]
    v_add_u32 v15, s78, v13
    v_xor_b32 v16, 32, v15
    v_add_u32 v17, s76, v14
    s_add_u32 s76, s76, 20544
    s_cmp_ge_u32 s76, 151872
    s_cselect_b32 s76, 49152, s76
    v_mfma_f32_32x32x16_bf16 v[144:159], v[92:95], v[80:83], v[144:159]
    ds_read_b128 v[32:35], v15
    ds_read_b128 v[36:39], v16
    ds_read_b64_tr_b16 v[40:41], v17 offset:0
    ds_read_b64_tr_b16 v[42:43], v17 offset:1280
    v_mfma_f32_32x32x16_bf16 v[160:175], v[96:99], v[80:83], v[160:175]
    ds_read_b64_tr_b16 v[44:45], v17 offset:32
    ds_read_b64_tr_b16 v[46:47], v17 offset:1312
    ds_read_b64_tr_b16 v[48:49], v17 offset:64
    ds_read_b64_tr_b16 v[50:51], v17 offset:1344
    v_mfma_f32_32x32x16_bf16 v[176:191], v[100:103], v[80:83], v[176:191]
    ds_read_b64_tr_b16 v[52:53], v17 offset:96
    ds_read_b64_tr_b16 v[54:55], v17 offset:1376
    ds_read_b64_tr_b16 v[56:57], v17 offset:128
    ds_read_b64_tr_b16 v[58:59], v17 offset:1408
    v_mfma_f32_32x32x16_bf16 v[192:207], v[104:107], v[80:83], v[192:207]
    ds_read_b64_tr_b16 v[60:61], v17 offset:5120
    ds_read_b64_tr_b16 v[62:63], v17 offset:6400
    ds_read_b64_tr_b16 v[64:65], v17 offset:5152
    ds_read_b64_tr_b16 v[66:67], v17 offset:6432
    v_mfma_f32_32x32x16_bf16 v[128:143], v[108:111], v[84:87], v[128:143]
    ds_read_b64_tr_b16 v[68:69], v17 offset:5184
    ds_read_b64_tr_b16 v[70:71], v17 offset:6464
    ds_read_b64_tr_b16 v[72:73], v17 offset:5216
    ds_read_b64_tr_b16 v[74:75], v17 offset:6496
    v_mfma_f32_32x32x16_bf16 v[144:159], v[112:115], v[84:87], v[144:159]
    ds_read_b64_tr_b16 v[76:77], v17 offset:5248
    ds_read_b64_tr_b16 v[78:79], v17 offset:6528
    v_mfma_f32_32x32x16_bf16 v[160:175], v[116:119], v[84:87], v[160:175]
    v_mfma_f32_32x32x16_bf16 v[176:191], v[120:123], v[84:87], v[176:191]
    v_mfma_f32_32x32x16_bf16 v[192:207], v[124:127], v[84:87], v[192:207]
    s_waitcnt lgkmcnt(0)
    v_mfma_f32_32x32x16_bf16 v[128:143], v[40:43], v[32:35], v[128:143]
    v_add_u32 v15, s78, v13
    v_xor_b32 v15, 64, v15
    v_xor_b32 v16, 32, v15
    v_add_u32 v17, s76, v14
    s_add_u32 s76, s76, 20544
    s_cmp_ge_u32 s76, 151872
    s_cselect_b32 s76, 49152, s76
    s_add_u32 s78, s78, 16384
    s_cmp_ge_u32 s78, 49152
    s_cselect_b32 s78, 0, s78
    v_mfma_f32_32x32x16_bf16 v[144:159], v[44:47], v[32:35], v[144:159]
    ds_read_b128 v[80:83], v15
    ds_read_b128 v[84:87], v16
    ds_read_b64_tr_b16 v[88:89], v17 offset:0
    ds_read_b64_tr_b16 v[90:91], v17 offset:1280
    v_mfma_f32_32x32x16_bf16 v[160:175], v[48:51], v[32:35], v[160:175]
    ds_read_b64_tr_b16 v[92:93], v17 offset:32
    ds_read_b64_tr_b16 v[94:95], v17 offset:1312
    ds_read_b64_tr_b16 v[96:97], v17 offset:64
    ds_read_b64_tr_b16 v[98:99], v17 offset:1344
    v_mfma_f32_32x32x16_bf16 v[176:191], v[52:55], v[32:35], v[176:191]
    ds_read_b64_tr_b16 v[100:101], v17 offset:96
    ds_read_b64_tr_b16 v[102:103], v17 offset:1376
    ds_read_b64_tr_b16 v[104:105], v17 offset:128
    ds_read_b64_tr_b16 v[106:107], v17 offset:1408
    v_mfma_f32_32x32x16_bf16 v[192:207], v[56:59], v[32:35], v[192:207]
    ds_read_b64_tr_b16 v[108:109], v17 offset:5120
    ds_read_b64_tr_b16 v[110:111], v17 offset:6400
    ds_read_b64_tr_b16 v[112:113], v17 offset:5152
    ds_read_b64_tr_b16 v[114:115], v17 offset:6432
    v_mfma_f32_32x32x16_bf16 v[128:143], v[60:63], v[36:39], v[128:143]
    ds_read_b64_tr_b16 v[116:117], v17 offset:5184
    ds_read_b64_tr_b16 v[118:119], v17 offset:6464
    ds_read_b64_tr_b16 v[120:121], v17 offset:5216
    ds_read_b64_tr_b16 v[122:123], v17 offset:6496
    v_mfma_f32_32x32x16_bf16 v[144:159], v[64:67], v[36:39], v[144:159]
    ds_read_b64_tr_b16 v[124:125], v17 offset:5248
    ds_read_b64_tr_b16 v[126:127], v17 offset:6528
    v_mfma_f32_32x32x16_bf16 v[160:175], v[68:71], v[36:39], v[160:175]
    v_mfma_f32_32x32x16_bf16 v[176:191], v[72:75], v[36:39], v[176:191]
    v_readfirstlane_b32 s10, v247
    s_cmp_lg_u32 s10, 0
    s_cbranch_scc1 K1_EN1_FEA
    v_mov_b32 v3, 0
    s_mov_b32 s11, 30000
K1_EN0_FEA:
    global_load_dword v247, v3, s[44:45] sc1
    s_waitcnt vmcnt(0)
    v_readfirstlane_b32 s10, v247
    s_sub_u32 s11, s11, 1
    s_cmp_eq_u32 s11, 0
    s_cbranch_scc1 K1_EN1_FEA
    s_cmp_eq_u32 s10, 0
    s_cbranch_scc1 K1_EN0_FEA
K1_EN1_FEA:
    s_mov_b32 s77, 30000
K1F_CHKA:
    s_waitcnt vmcnt(0)
    v_not_b32 v3, v247
    v_cmp_eq_u32 s[10:11], v230, v247
    v_cmp_eq_u32 vcc, v231, v3
    s_and_b64 s[10:11], s[10:11], vcc
    v_mov_b32 v4, 0x7ffffff0
    v_cmp_eq_u32 s[12:13], v4, v29
    s_mov_b64 s[14:15], -1
    v_cmp_eq_u32 vcc, v209, v247
    s_and_b64 s[14:15], s[14:15], vcc
    v_cmp_eq_u32 vcc, v211, v247
    s_and_b64 s[14:15], s[14:15], vcc
    v_cmp_eq_u32 vcc, v213, v247
    s_and_b64 s[14:15], s[14:15], vcc
    v_cmp_eq_u32 vcc, v215, v247
    s_and_b64 s[14:15], s[14:15], vcc
    v_cmp_eq_u32 vcc, v217, v247
    s_and_b64 s[14:15], s[14:15], vcc
    v_cmp_eq_u32 vcc, v219, v247
    s_and_b64 s[14:15], s[14:15], vcc
    v_cmp_eq_u32 vcc, v221, v247
    s_and_b64 s[14:15], s[14:15], vcc
    v_cmp_eq_u32 vcc, v223, v247
    s_and_b64 s[14:15], s[14:15], vcc
    v_cmp_eq_u32 vcc, v225, v247
    s_and_b64 s[14:15], s[14:15], vcc
    v_cmp_eq_u32 vcc, v227, v247
    s_and_b64 s[14:15], s[14:15], vcc
    s_or_b64 s[14:15], s[14:15], s[12:13]
    s_and_b64 s[10:11], s[10:11], s[14:15]
    s_cmp_eq_u64 s[10:11], -1
    s_cbranch_scc1 K1F_OKA
    s_sub_u32 s77, s77, 1
    s_cmp_eq_u32 s77, 0
    s_cbranch_scc1 K1F_OKA
    s_sleep 1
    s_add_u32 s12, s88, 0
    buffer_load_dwordx2 v[208:209], v29, s[80:83], s12 offen sc1
    s_add_u32 s12, s88, 2560
    buffer_load_dwordx2 v[210:211], v29, s[80:83], s12 offen sc1
    s_add_u32 s12, s88, 5120
    buffer_load_dwordx2 v[212:213], v29, s[80:83], s12 offen sc1
    s_add_u32 s12, s88, 7680
    buffer_load_dwordx2 v[214:215], v29, s[80:83], s12 offen sc1
    s_add_u32 s12, s88, 10240
    buffer_load_dwordx2 v[216:217], v29, s[80:83], s12 offen sc1
    s_add_u32 s12, s88, 12800
    buffer_load_dwordx2 v[218:219], v29, s[80:83], s12 offen sc1
    s_add_u32 s12, s88, 15360
    buffer_load_dwordx2 v[220:221], v29, s[80:83], s12 offen sc1
    s_add_u32 s12, s88, 17920
    buffer_load_dwordx2 v[222:223], v29, s[80:83], s12 offen sc1
    s_add_u32 s12, s88, 20480
    buffer_load_dwordx2 v[224:225], v29, s[80:83], s12 offen sc1
    s_add_u32 s12, s88, 23040
    buffer_load_dwordx2 v[226:227], v29, s[80:83], s12 offen sc1
    buffer_load_dwordx4 v[228:231], v30, s[84:87], 0 offen sc1
    s_branch K1F_CHKA
K1F_OKA:
    v_add_f32 v208, v208, v210
    v_add_f32 v208, v208, v212
    v_add_f32 v208, v208, v214
    v_add_f32 v208, v208, v216
    v_add_f32 v208, v208, v218
    v_add_f32 v208, v208, v220
    v_add_f32 v208, v208, v222
    v_add_f32 v208, v208, v224
    v_add_f32 v208, v208, v226
    v_lshlrev_b32 v4, 2, v0
    v_cmp_gt_u32 vcc, 320, v0
    s_and_saveexec_b64 s[10:11], vcc
    v_add_u32 v4, 162112, v4
    ds_write_b32 v4, v208
    s_mov_b64 exec, s[10:11]
    s_lshr_b32 s10, s2, 3
    s_lshl_b32 s10, s10, 7
    s_add_u32 s10, s10, 32505856
    v_mov_b32 v1, s10
    global_load_dword v1, v1, s[46:47] sc1
    v_mfma_f32_32x32x16_bf16 v[192:207], v[76:79], v[36:39], v[192:207]
    s_waitcnt lgkmcnt(0)
    v_mfma_f32_32x32x16_bf16 v[128:143], v[88:91], v[80:83], v[128:143]
    v_mfma_f32_32x32x16_bf16 v[144:159], v[92:95], v[80:83], v[144:159]
    v_mfma_f32_32x32x16_bf16 v[160:175], v[96:99], v[80:83], v[160:175]
    v_mfma_f32_32x32x16_bf16 v[176:191], v[100:103], v[80:83], v[176:191]
    v_mfma_f32_32x32x16_bf16 v[192:207], v[104:107], v[80:83], v[192:207]
    v_mfma_f32_32x32x16_bf16 v[128:143], v[108:111], v[84:87], v[128:143]
    v_mfma_f32_32x32x16_bf16 v[144:159], v[112:115], v[84:87], v[144:159]
    v_mfma_f32_32x32x16_bf16 v[160:175], v[116:119], v[84:87], v[160:175]
    v_mfma_f32_32x32x16_bf16 v[176:191], v[120:123], v[84:87], v[176:191]
    v_mfma_f32_32x32x16_bf16 v[192:207], v[124:127], v[84:87], v[192:207]
    s_branch K1F_EPI
HK_FA_I:
    s_cmp_lg_u32 s91, 0
    s_cselect_b32 s92, s28, s26
    s_cselect_b32 s93, s29, s27
    s_mov_b32 s94, 819200
    s_mov_b32 s95, 0x20000
    buffer_load_dwordx4 v[248:251], v232, s[92:95], s89 offen
    s_mul_i32 s13, s6, 11
    s_add_u32 s13, s13, s7
    s_cmp_ge_u32 s13, 24
    s_cbranch_scc1 K1_NOC_7
    s_cmp_lg_u32 s14, 0
    s_cselect_b32 s92, s28, s26
    s_cselect_b32 s93, s29, s27
    s_mov_b32 s94, 819200
    s_mov_b32 s95, 0x20000
    buffer_load_dwordx4 v[240:243], v244, s[92:95], s8 offen
K1_NOC_7:
    s_sub_u32 s13, s3, 1
    s_cmp_ge_u32 s13, 2
    s_cbranch_scc1 K1_NOW_8
    s_mov_b32 s92, s40
    s_mov_b32 s93, s41
    s_mov_b32 s94, 2211840
    s_mov_b32 s95, 0x20000
    s_mul_i32 s13, s13, 5120
    s_add_u32 s13, s13, 151872
    s_add_u32 m0, s13, 0
    s_nop 0
    buffer_load_dwordx4 v233, s[92:95], s90 offen lds
    s_add_u32 m0, s13, 1024
    s_nop 0
    buffer_load_dwordx4 v234, s[92:95], s90 offen lds
    s_add_u32 m0, s13, 2048
    s_nop 0
    buffer_load_dwordx4 v235, s[92:95], s90 offen lds
    s_add_u32 m0, s13, 3072
    s_nop 0
    buffer_load_dwordx4 v236, s[92:95], s90 offen lds
    s_add_u32 m0, s13, 4096
    s_nop 0
    buffer_load_dwordx4 v237, s[92:95], s90 offen lds
K1_NOW_8:
    s_branch HK_FA_I_B
HK_FA_F:
    v_lshlrev_b32 v228, 4, v2
    v_and_b32 v4, 15, v2
    v_lshlrev_b32 v4, 4, v4
    v_lshrrev_b32 v3, 4, v2
    v_lshl_add_u32 v4, v3, 2, v4
    ds_bpermute_b32 v208, v4, v248
    ds_bpermute_b32 v209, v4, v249
    ds_bpermute_b32 v210, v4, v250
    ds_bpermute_b32 v211, v4, v251
    ds_bpermute_b32 v212, v4, v240
    ds_bpermute_b32 v213, v4, v241
    ds_bpermute_b32 v214, v4, v242
    ds_bpermute_b32 v215, v4, v243
    s_waitcnt lgkmcnt(0)
    buffer_store_dwordx4 v[208:211], v228, s[96:99], s100 offen sc1
    s_mul_i32 s13, s6, 11
    s_add_u32 s13, s13, s7
    s_cmp_ge_u32 s13, 24
    s_cbranch_scc1 K1_SF1_9
    buffer_store_dwordx4 v[212:215], v228, s[96:99], s9 offen sc1
K1_SF1_9:
    s_nop 1
    s_sub_u32 s13, s3, 1
    s_cmp_ge_u32 s13, 2
    s_cbranch_scc1 K1_SF2_10
    v_lshrrev_b32 v229, 5, v2
    v_lshlrev_b32 v229, 4, v229
    v_bfe_u32 v4, v2, 4, 1
    v_lshl_add_u32 v229, v4, 2, v229
    v_bfe_u32 v4, v2, 2, 2
    v_add_u32 v229, v229, v4
    v_mul_u32_u24 v229, 160, v229
    v_and_b32 v4, 3, v2
    v_lshl_add_u32 v229, v4, 3, v229
    s_mul_i32 s13, s13, 5120
    s_add_u32 s13, s13, 151872
    v_add_u32 v229, s13, v229
    ds_read_b64_tr_b16 v[208:209], v229 offset:0
    ds_read_b64_tr_b16 v[210:211], v229 offset:1280
    ds_read_b64_tr_b16 v[212:213], v229 offset:32
    ds_read_b64_tr_b16 v[214:215], v229 offset:1312
    ds_read_b64_tr_b16 v[216:217], v229 offset:64
    ds_read_b64_tr_b16 v[218:219], v229 offset:1344
    ds_read_b64_tr_b16 v[220:221], v229 offset:96
    ds_read_b64_tr_b16 v[222:223], v229 offset:1376
    ds_read_b64_tr_b16 v[224:225], v229 offset:128
    ds_read_b64_tr_b16 v[226:227], v229 offset:1408
    s_waitcnt lgkmcnt(0)
    s_add_u32 s13, s101, 0
    buffer_store_dwordx4 v[208:211], v228, s[96:99], s13 offen sc1
    s_add_u32 s13, s101, 1024
    buffer_store_dwordx4 v[212:215], v228, s[96:99], s13 offen sc1
    s_add_u32 s13, s101, 2048
    buffer_store_dwordx4 v[216:219], v228, s[96:99], s13 offen sc1
    s_add_u32 s13, s101, 3072
    buffer_store_dwordx4 v[220:223], v228, s[96:99], s13 offen sc1
    s_add_u32 s13, s101, 4096
    buffer_store_dwordx4 v[224:227], v228, s[96:99], s13 offen sc1
K1_SF2_10:
    s_branch HK_FA_F_B
HK_FA_A:
    s_cmp_eq_u32 s3, 0
    s_cbranch_scc0 K1_AI_CBFA
    s_mov_b32 s10, 32
    v_mov_b32 v31, s10
    v_mov_b32 v27, 1
    s_mov_b64 s[12:13], exec
    s_mov_b64 exec, 1
    global_atomic_add v31, v31, v27, s[44:45] sc0 sc1
    s_mov_b64 exec, s[12:13]
K1_AI_CBFA:
    s_branch HK_FA_A_B
K1F_B:
    s_waitcnt vmcnt(9) lgkmcnt(0)
    s_barrier
    v_mfma_f32_32x32x16_bf16 v[128:143], v[40:43], v[32:35], v[128:143]
    v_add_u32 v15, s78, v13
    v_xor_b32 v15, 64, v15
    v_xor_b32 v16, 32, v15
    v_add_u32 v17, s76, v14
    s_add_u32 s76, s76, 20544
    s_cmp_ge_u32 s76, 151872
    s_cselect_b32 s76, 49152, s76
    s_add_u32 s78, s78, 16384
    s_cmp_ge_u32 s78, 49152
    s_cselect_b32 s78, 0, s78
    v_mfma_f32_32x32x16_bf16 v[144:159], v[44:47], v[32:35], v[144:159]
    ds_read_b128 v[80:83], v15
    ds_read_b128 v[84:87], v16
    ds_read_b64_tr_b16 v[88:89], v17 offset:0
    ds_read_b64_tr_b16 v[90:91], v17 offset:1280
    s_add_u32 m0, s75, s70
    s_nop 0
    buffer_load_dwordx4 v10, s[52:55], s73 offen lds
    v_mfma_f32_32x32x16_bf16 v[160:175], v[48:51], v[32:35], v[160:175]
    ds_read_b64_tr_b16 v[92:93], v17 offset:32
    ds_read_b64_tr_b16 v[94:95], v17 offset:1312
    ds_read_b64_tr_b16 v[96:97], v17 offset:64
    ds_read_b64_tr_b16 v[98:99], v17 offset:1344
    v_mfma_f32_32x32x16_bf16 v[176:191], v[52:55], v[32:35], v[176:191]
    ds_read_b64_tr_b16 v[100:101], v17 offset:96
    ds_read_b64_tr_b16 v[102:103], v17 offset:1376
    ds_read_b64_tr_b16 v[104:105], v17 offset:128
    ds_read_b64_tr_b16 v[106:107], v17 offset:1408
    s_add_u32 m0, s75, s71
    s_nop 0
    buffer_load_dwordx4 v11, s[56:59], s73 offen lds
    v_mfma_f32_32x32x16_bf16 v[192:207], v[56:59], v[32:35], v[192:207]
    ds_read_b64_tr_b16 v[108:109], v17 offset:5120
    ds_read_b64_tr_b16 v[110:111], v17 offset:6400
    ds_read_b64_tr_b16 v[112:113], v17 offset:5152
    ds_read_b64_tr_b16 v[114:115], v17 offset:6432
    v_mfma_f32_32x32x16_bf16 v[128:143], v[60:63], v[36:39], v[128:143]
    ds_read_b64_tr_b16 v[116:117], v17 offset:5184
    ds_read_b64_tr_b16 v[118:119], v17 offset:6464
    ds_read_b64_tr_b16 v[120:121], v17 offset:5216
    ds_read_b64_tr_b16 v[122:123], v17 offset:6496
    v_mfma_f32_32x32x16_bf16 v[144:159], v[64:67], v[36:39], v[144:159]
    ds_read_b64_tr_b16 v[124:125], v17 offset:5248
    ds_read_b64_tr_b16 v[126:127], v17 offset:6528
    v_mfma_f32_32x32x16_bf16 v[160:175], v[68:71], v[36:39], v[160:175]
    v_mfma_f32_32x32x16_bf16 v[176:191], v[72:75], v[36:39], v[176:191]
    s_add_u32 s73, s73, 110592
    s_sub_u32 s12, s73, 2211840
    s_cmp_ge_u32 s73, s1
    s_cselect_b32 s73, s12, s73
    s_add_u32 s75, s75, 20544
    s_cmp_ge_u32 s75, 151872
    s_cselect_b32 s75, 49152, s75
    s_cmp_eq_u32 s68, 0
    s_cbranch_scc1 K1C_11
    v_dot2c_f32_bf16 v21, v40, v18
    v_dot2c_f32_bf16 v22, v44, v18
    v_dot2c_f32_bf16 v23, v48, v18
    v_dot2c_f32_bf16 v24, v52, v18
    v_dot2c_f32_bf16 v25, v56, v18
    v_dot2c_f32_bf16 v21, v41, v18
    v_dot2c_f32_bf16 v22, v45, v18
    v_dot2c_f32_bf16 v23, v49, v18
    v_dot2c_f32_bf16 v24, v53, v18
    v_dot2c_f32_bf16 v25, v57, v18
    v_dot2c_f32_bf16 v21, v42, v18
    v_dot2c_f32_bf16 v22, v46, v18
    v_dot2c_f32_bf16 v23, v50, v18
    v_dot2c_f32_bf16 v24, v54, v18
    v_dot2c_f32_bf16 v25, v58, v18
    v_dot2c_f32_bf16 v21, v43, v18
    v_dot2c_f32_bf16 v22, v47, v18
    v_dot2c_f32_bf16 v23, v51, v18
    v_dot2c_f32_bf16 v24, v55, v18
    v_dot2c_f32_bf16 v25, v59, v18
    v_dot2c_f32_bf16 v21, v60, v18
    v_dot2c_f32_bf16 v22, v64, v18
    v_dot2c_f32_bf16 v23, v68, v18
    v_dot2c_f32_bf16 v24, v72, v18
    v_dot2c_f32_bf16 v25, v76, v18
    v_dot2c_f32_bf16 v21, v61, v18
    v_dot2c_f32_bf16 v22, v65, v18
    v_dot2c_f32_bf16 v23, v69, v18
    v_dot2c_f32_bf16 v24, v73, v18
    v_dot2c_f32_bf16 v25, v77, v18
    v_dot2c_f32_bf16 v21, v62, v18
    v_dot2c_f32_bf16 v22, v66, v18
    v_dot2c_f32_bf16 v23, v70, v18
    v_dot2c_f32_bf16 v24, v74, v18
    v_dot2c_f32_bf16 v25, v78, v18
    v_dot2c_f32_bf16 v21, v63, v18
    v_dot2c_f32_bf16 v22, v67, v18
    v_dot2c_f32_bf16 v23, v71, v18
    v_dot2c_f32_bf16 v24, v75, v18
    v_dot2c_f32_bf16 v25, v79, v18
K1C_11:
    v_mfma_f32_32x32x16_bf16 v[192:207], v[76:79], v[36:39], v[192:207]
    s_waitcnt vmcnt(2) lgkmcnt(0)
    s_barrier
    v_mfma_f32_32x32x16_bf16 v[128:143], v[88:91], v[80:83], v[128:143]
    v_add_u32 v15, s78, v13
    v_xor_b32 v16, 32, v15
    v_add_u32 v17, s76, v14
    s_add_u32 s76, s76, 20544
    s_cmp_ge_u32 s76, 151872
    s_cselect_b32 s76, 49152, s76
    v_mfma_f32_32x32x16_bf16 v[144:159], v[92:95], v[80:83], v[144:159]
    ds_read_b128 v[32:35], v15
    ds_read_b128 v[36:39], v16
    ds_read_b64_tr_b16 v[40:41], v17 offset:0
    ds_read_b64_tr_b16 v[42:43], v17 offset:1280
    s_add_u32 m0, s75, s70
    s_nop 0
    buffer_load_dwordx4 v10, s[52:55], s73 offen lds
    v_mfma_f32_32x32x16_bf16 v[160:175], v[96:99], v[80:83], v[160:175]
    ds_read_b64_tr_b16 v[44:45], v17 offset:32
    ds_read_b64_tr_b16 v[46:47], v17 offset:1312
    ds_read_b64_tr_b16 v[48:49], v17 offset:64
    ds_read_b64_tr_b16 v[50:51], v17 offset:1344
    v_mfma_f32_32x32x16_bf16 v[176:191], v[100:103], v[80:83], v[176:191]
    ds_read_b64_tr_b16 v[52:53], v17 offset:96
    ds_read_b64_tr_b16 v[54:55], v17 offset:1376
    ds_read_b64_tr_b16 v[56:57], v17 offset:128
    ds_read_b64_tr_b16 v[58:59], v17 offset:1408
    s_add_u32 m0, s75, s71
    s_nop 0
    buffer_load_dwordx4 v11, s[56:59], s73 offen lds
    v_mfma_f32_32x32x16_bf16 v[192:207], v[104:107], v[80:83], v[192:207]
    ds_read_b64_tr_b16 v[60:61], v17 offset:5120
    ds_read_b64_tr_b16 v[62:63], v17 offset:6400
    ds_read_b64_tr_b16 v[64:65], v17 offset:5152
    ds_read_b64_tr_b16 v[66:67], v17 offset:6432
    v_mfma_f32_32x32x16_bf16 v[128:143], v[108:111], v[84:87], v[128:143]
    ds_read_b64_tr_b16 v[68:69], v17 offset:5184
    ds_read_b64_tr_b16 v[70:71], v17 offset:6464
    ds_read_b64_tr_b16 v[72:73], v17 offset:5216
    ds_read_b64_tr_b16 v[74:75], v17 offset:6496
    s_add_u32 m0, s79, s69
    s_nop 0
    buffer_load_dwordx4 v8, s[48:51], s74 offen lds
    v_mfma_f32_32x32x16_bf16 v[144:159], v[112:115], v[84:87], v[144:159]
    ds_read_b64_tr_b16 v[76:77], v17 offset:5248
    ds_read_b64_tr_b16 v[78:79], v17 offset:6528
    s_add_u32 m0, s79, s69
    s_add_u32 m0, m0, 1024
    s_nop 0
    buffer_load_dwordx4 v9, s[48:51], s74 offen lds
    v_mfma_f32_32x32x16_bf16 v[160:175], v[116:119], v[84:87], v[160:175]
    v_mfma_f32_32x32x16_bf16 v[176:191], v[120:123], v[84:87], v[176:191]
    s_add_u32 s73, s73, 110592
    s_sub_u32 s12, s73, 2211840
    s_cmp_ge_u32 s73, s1
    s_cselect_b32 s73, s12, s73
    s_add_u32 s75, s75, 20544
    s_cmp_ge_u32 s75, 151872
    s_cselect_b32 s75, 49152, s75
    s_add_u32 s74, s74, 128
    s_cmp_ge_u32 s74, 1280
    s_cselect_b32 s74, 0, s74
    s_add_u32 s79, s79, 16384
    s_cmp_ge_u32 s79, 49152
    s_cselect_b32 s79, 0, s79
    s_cmp_eq_u32 s68, 0
    s_cbranch_scc1 K1C_12
    v_dot2c_f32_bf16 v21, v88, v18
    v_dot2c_f32_bf16 v22, v92, v18
    v_dot2c_f32_bf16 v23, v96, v18
    v_dot2c_f32_bf16 v24, v100, v18
    v_dot2c_f32_bf16 v25, v104, v18
    v_dot2c_f32_bf16 v21, v89, v18
    v_dot2c_f32_bf16 v22, v93, v18
    v_dot2c_f32_bf16 v23, v97, v18
    v_dot2c_f32_bf16 v24, v101, v18
    v_dot2c_f32_bf16 v25, v105, v18
    v_dot2c_f32_bf16 v21, v90, v18
    v_dot2c_f32_bf16 v22, v94, v18
    v_dot2c_f32_bf16 v23, v98, v18
    v_dot2c_f32_bf16 v24, v102, v18
    v_dot2c_f32_bf16 v25, v106, v18
    v_dot2c_f32_bf16 v21, v91, v18
    v_dot2c_f32_bf16 v22, v95, v18
    v_dot2c_f32_bf16 v23, v99, v18
    v_dot2c_f32_bf16 v24, v103, v18
    v_dot2c_f32_bf16 v25, v107, v18
    v_dot2c_f32_bf16 v21, v108, v18
    v_dot2c_f32_bf16 v22, v112, v18
    v_dot2c_f32_bf16 v23, v116, v18
    v_dot2c_f32_bf16 v24, v120, v18
    v_dot2c_f32_bf16 v25, v124, v18
    v_dot2c_f32_bf16 v21, v109, v18
    v_dot2c_f32_bf16 v22, v113, v18
    v_dot2c_f32_bf16 v23, v117, v18
    v_dot2c_f32_bf16 v24, v121, v18
    v_dot2c_f32_bf16 v25, v125, v18
    v_dot2c_f32_bf16 v21, v110, v18
    v_dot2c_f32_bf16 v22, v114, v18
    v_dot2c_f32_bf16 v23, v118, v18
    v_dot2c_f32_bf16 v24, v122, v18
    v_dot2c_f32_bf16 v25, v126, v18
    v_dot2c_f32_bf16 v21, v111, v18
    v_dot2c_f32_bf16 v22, v115, v18
    v_dot2c_f32_bf16 v23, v119, v18
    v_dot2c_f32_bf16 v24, v123, v18
    v_dot2c_f32_bf16 v25, v127, v18
    v_mov_b32 v208, v21
    v_mov_b32 v210, v22
    v_mov_b32 v212, v23
    v_mov_b32 v214, v24
    v_mov_b32 v216, v25
    s_nop 1
    v_permlane32_swap_b32 v21, v208
    v_permlane32_swap_b32 v22, v210
    v_permlane32_swap_b32 v23, v212
    v_permlane32_swap_b32 v24, v214
    v_permlane32_swap_b32 v25, v216
    v_add_f32 v208, v21, v208
    v_add_f32 v210, v22, v210
    v_add_f32 v212, v23, v212
    v_add_f32 v214, v24, v214
    v_add_f32 v216, v25, v216
    v_readfirstlane_b32 s10, v247
    s_cmp_lg_u32 s10, 0
    s_cbranch_scc1 K1_EN1_FCB
    v_mov_b32 v3, 0
    s_mov_b32 s11, 30000
K1_EN0_FCB:
    global_load_dword v247, v3, s[44:45] sc1
    s_waitcnt vmcnt(0)
    v_readfirstlane_b32 s10, v247
    s_sub_u32 s11, s11, 1
    s_cmp_eq_u32 s11, 0
    s_cbranch_scc1 K1_EN1_FCB
    s_cmp_eq_u32 s10, 0
    s_cbranch_scc1 K1_EN0_FCB
K1_EN1_FCB:
    v_mov_b32 v209, v247
    v_mov_b32 v211, v247
    v_mov_b32 v213, v247
    v_mov_b32 v215, v247
    v_mov_b32 v217, v247
    v_and_b32 v3, 31, v2
    s_mul_i32 s10, s5, 160
    v_add_u32 v3, s10, v3
    v_lshlrev_b32 v3, 3, v3
    s_mul_i32 s10, s0, 2560
    s_add_u32 s10, s10, s88
    s_mov_b32 exec_hi, 0
    buffer_store_dwordx2 v[208:209], v3, s[80:83], s10 offen offset:0 sc1
    buffer_store_dwordx2 v[210:211], v3, s[80:83], s10 offen offset:256 sc1
    buffer_store_dwordx2 v[212:213], v3, s[80:83], s10 offen offset:512 sc1
    buffer_store_dwordx2 v[214:215], v3, s[80:83], s10 offen offset:768 sc1
    buffer_store_dwordx2 v[216:217], v3, s[80:83], s10 offen offset:1024 sc1
    s_mov_b32 exec_hi, -1
K1C_12:
    s_mov_b32 s77, 1
    s_cmp_lt_u32 s3, 6
    s_cbranch_scc1 K1_SP_FB
    s_cmp_eq_u32 s77, 1
    s_cbranch_scc0 K1_SP_FB
    v_readfirstlane_b32 s10, v247
    s_cmp_lg_u32 s10, 0
    s_cbranch_scc1 K1_EN1_FBP
    v_mov_b32 v3, 0
    s_mov_b32 s11, 30000
K1_EN0_FBP:
    global_load_dword v247, v3, s[44:45] sc1
    s_waitcnt vmcnt(0)
    v_readfirstlane_b32 s10, v247
    s_sub_u32 s11, s11, 1
    s_cmp_eq_u32 s11, 0
    s_cbranch_scc1 K1_EN1_FBP
    s_cmp_eq_u32 s10, 0
    s_cbranch_scc1 K1_EN0_FBP
K1_EN1_FBP:
    v_mov_b32 v240, v238
    v_mov_b32 v241, v239
    v_mov_b32 v242, v247
    v_not_b32 v243, v247
    v_lshlrev_b32 v3, 4, v28
    v_and_b32 v4, 15, v2
    v_cmp_eq_u32 vcc, 0, v4
    s_and_saveexec_b64 s[10:11], vcc
    buffer_store_dwordx4 v[240:243], v3, s[84:87], 0 offen sc1
    s_mov_b64 exec, s[10:11]
K1_SP_FB:
    v_mfma_f32_32x32x16_bf16 v[192:207], v[124:127], v[84:87], v[192:207]
    s_mov_b32 s77, 6
K1F_LOOP_B:
    s_waitcnt lgkmcnt(0)
    v_mfma_f32_32x32x16_bf16 v[128:143], v[40:43], v[32:35], v[128:143]
    v_add_u32 v15, s78, v13
    v_xor_b32 v15, 64, v15
    v_xor_b32 v16, 32, v15
    v_add_u32 v17, s76, v14
    s_add_u32 s76, s76, 20544
    s_cmp_ge_u32 s76, 151872
    s_cselect_b32 s76, 49152, s76
    s_add_u32 s78, s78, 16384
    s_cmp_ge_u32 s78, 49152
    s_cselect_b32 s78, 0, s78
    v_mfma_f32_32x32x16_bf16 v[144:159], v[44:47], v[32:35], v[144:159]
    ds_read_b128 v[80:83], v15
    ds_read_b128 v[84:87], v16
    ds_read_b64_tr_b16 v[88:89], v17 offset:0
    ds_read_b64_tr_b16 v[90:91], v17 offset:1280
    s_add_u32 m0, s75, s70
    s_nop 0
    buffer_load_dwordx4 v10, s[52:55], s73 offen lds
    v_mfma_f32_32x32x16_bf16 v[160:175], v[48:51], v[32:35], v[160:175]
    ds_read_b64_tr_b16 v[92:93], v17 offset:32
    ds_read_b64_tr_b16 v[94:95], v17 offset:1312
    ds_read_b64_tr_b16 v[96:97], v17 offset:64
    ds_read_b64_tr_b16 v[98:99], v17 offset:1344
    v_mfma_f32_32x32x16_bf16 v[176:191], v[52:55], v[32:35], v[176:191]
    ds_read_b64_tr_b16 v[100:101], v17 offset:96
    ds_read_b64_tr_b16 v[102:103], v17 offset:1376
    ds_read_b64_tr_b16 v[104:105], v17 offset:128
    ds_read_b64_tr_b16 v[106:107], v17 offset:1408
    s_add_u32 m0, s75, s71
    s_nop 0
    buffer_load_dwordx4 v11, s[56:59], s73 offen lds
    v_mfma_f32_32x32x16_bf16 v[192:207], v[56:59], v[32:35], v[192:207]
    ds_read_b64_tr_b16 v[108:109], v17 offset:5120
    ds_read_b64_tr_b16 v[110:111], v17 offset:6400
    ds_read_b64_tr_b16 v[112:113], v17 offset:5152
    ds_read_b64_tr_b16 v[114:115], v17 offset:6432
    v_mfma_f32_32x32x16_bf16 v[128:143], v[60:63], v[36:39], v[128:143]
    ds_read_b64_tr_b16 v[116:117], v17 offset:5184
    ds_read_b64_tr_b16 v[118:119], v17 offset:6464
    ds_read_b64_tr_b16 v[120:121], v17 offset:5216
    ds_read_b64_tr_b16 v[122:123], v17 offset:6496
    v_mfma_f32_32x32x16_bf16 v[144:159], v[64:67], v[36:39], v[144:159]
    ds_read_b64_tr_b16 v[124:125], v17 offset:5248
    ds_read_b64_tr_b16 v[126:127], v17 offset:6528
    v_mfma_f32_32x32x16_bf16 v[160:175], v[68:71], v[36:39], v[160:175]
    v_mfma_f32_32x32x16_bf16 v[176:191], v[72:75], v[36:39], v[176:191]
    s_add_u32 s73, s73, 110592
    s_sub_u32 s12, s73, 2211840
    s_cmp_ge_u32 s73, s1
    s_cselect_b32 s73, s12, s73
    s_add_u32 s75, s75, 20544
    s_cmp_ge_u32 s75, 151872
    s_cselect_b32 s75, 49152, s75
    v_mfma_f32_32x32x16_bf16 v[192:207], v[76:79], v[36:39], v[192:207]
    s_waitcnt vmcnt(2) lgkmcnt(0)
    s_barrier
    v_mfma_f32_32x32x16_bf16 v[128:143], v[88:91], v[80:83], v[128:143]
    v_add_u32 v15, s78, v13
    v_xor_b32 v16, 32, v15
    v_add_u32 v17, s76, v14
    s_add_u32 s76, s76, 20544
    s_cmp_ge_u32 s76, 151872
    s_cselect_b32 s76, 49152, s76
    v_mfma_f32_32x32x16_bf16 v[144:159], v[92:95], v[80:83], v[144:159]
    ds_read_b128 v[32:35], v15
    ds_read_b128 v[36:39], v16
    ds_read_b64_tr_b16 v[40:41], v17 offset:0
    ds_read_b64_tr_b16 v[42:43], v17 offset:1280
    s_add_u32 m0, s75, s70
    s_nop 0
    buffer_load_dwordx4 v10, s[52:55], s73 offen lds
    v_mfma_f32_32x32x16_bf16 v[160:175], v[96:99], v[80:83], v[160:175]
    ds_read_b64_tr_b16 v[44:45], v17 offset:32
    ds_read_b64_tr_b16 v[46:47], v17 offset:1312
    ds_read_b64_tr_b16 v[48:49], v17 offset:64
    ds_read_b64_tr_b16 v[50:51], v17 offset:1344
    v_mfma_f32_32x32x16_bf16 v[176:191], v[100:103], v[80:83], v[176:191]
    ds_read_b64_tr_b16 v[52:53], v17 offset:96
    ds_read_b64_tr_b16 v[54:55], v17 offset:1376
    ds_read_b64_tr_b16 v[56:57], v17 offset:128
    ds_read_b64_tr_b16 v[58:59], v17 offset:1408
    s_add_u32 m0, s75, s71
    s_nop 0
    buffer_load_dwordx4 v11, s[56:59], s73 offen lds
    v_mfma_f32_32x32x16_bf16 v[192:207], v[104:107], v[80:83], v[192:207]
    ds_read_b64_tr_b16 v[60:61], v17 offset:5120
    ds_read_b64_tr_b16 v[62:63], v17 offset:6400
    ds_read_b64_tr_b16 v[64:65], v17 offset:5152
    ds_read_b64_tr_b16 v[66:67], v17 offset:6432
    v_mfma_f32_32x32x16_bf16 v[128:143], v[108:111], v[84:87], v[128:143]
    ds_read_b64_tr_b16 v[68:69], v17 offset:5184
    ds_read_b64_tr_b16 v[70:71], v17 offset:6464
    ds_read_b64_tr_b16 v[72:73], v17 offset:5216
    ds_read_b64_tr_b16 v[74:75], v17 offset:6496
    s_add_u32 m0, s79, s69
    s_nop 0
    buffer_load_dwordx4 v8, s[48:51], s74 offen lds
    v_mfma_f32_32x32x16_bf16 v[144:159], v[112:115], v[84:87], v[144:159]
    ds_read_b64_tr_b16 v[76:77], v17 offset:5248
    ds_read_b64_tr_b16 v[78:79], v17 offset:6528
    s_add_u32 m0, s79, s69
    s_add_u32 m0, m0, 1024
    s_nop 0
    buffer_load_dwordx4 v9, s[48:51], s74 offen lds
    v_mfma_f32_32x32x16_bf16 v[160:175], v[116:119], v[84:87], v[160:175]
    v_mfma_f32_32x32x16_bf16 v[176:191], v[120:123], v[84:87], v[176:191]
    s_add_u32 s73, s73, 110592
    s_sub_u32 s12, s73, 2211840
    s_cmp_ge_u32 s73, s1
    s_cselect_b32 s73, s12, s73
    s_add_u32 s75, s75, 20544
    s_cmp_ge_u32 s75, 151872
    s_cselect_b32 s75, 49152, s75
    s_add_u32 s74, s74, 128
    s_cmp_ge_u32 s74, 1280
    s_cselect_b32 s74, 0, s74
    s_add_u32 s79, s79, 16384
    s_cmp_ge_u32 s79, 49152
    s_cselect_b32 s79, 0, s79
    s_cmp_eq_u32 s77, 6
    s_cbranch_scc1 HK_FB_I
HK_FB_I_B:
    s_cmp_eq_u32 s77, 4
    s_cbranch_scc1 HK_FB_F
HK_FB_F_B:
    s_cmp_eq_u32 s77, 2
    s_cbranch_scc1 HK_FB_A
HK_FB_A_B:
    v_mfma_f32_32x32x16_bf16 v[192:207], v[124:127], v[84:87], v[192:207]
    s_sub_u32 s77, s77, 1
    s_cmp_lg_u32 s77, 0
    s_cbranch_scc1 K1F_LOOP_B
    s_waitcnt lgkmcnt(0)
    v_mfma_f32_32x32x16_bf16 v[128:143], v[40:43], v[32:35], v[128:143]
    v_add_u32 v15, s78, v13
    v_xor_b32 v15, 64, v15
    v_xor_b32 v16, 32, v15
    v_add_u32 v17, s76, v14
    s_add_u32 s76, s76, 20544
    s_cmp_ge_u32 s76, 151872
    s_cselect_b32 s76, 49152, s76
    s_add_u32 s78, s78, 16384
    s_cmp_ge_u32 s78, 49152
    s_cselect_b32 s78, 0, s78
    v_mfma_f32_32x32x16_bf16 v[144:159], v[44:47], v[32:35], v[144:159]
    ds_read_b128 v[80:83], v15
    ds_read_b128 v[84:87], v16
    ds_read_b64_tr_b16 v[88:89], v17 offset:0
    ds_read_b64_tr_b16 v[90:91], v17 offset:1280
    s_add_u32 m0, s75, s70
    s_nop 0
    buffer_load_dwordx4 v10, s[52:55], s73 offen lds
    v_mfma_f32_32x32x16_bf16 v[160:175], v[48:51], v[32:35], v[160:175]
    ds_read_b64_tr_b16 v[92:93], v17 offset:32
    ds_read_b64_tr_b16 v[94:95], v17 offset:1312
    ds_read_b64_tr_b16 v[96:97], v17 offset:64
    ds_read_b64_tr_b16 v[98:99], v17 offset:1344
    v_mfma_f32_32x32x16_bf16 v[176:191], v[52:55], v[32:35], v[176:191]
    ds_read_b64_tr_b16 v[100:101], v17 offset:96
    ds_read_b64_tr_b16 v[102:103], v17 offset:1376
    ds_read_b64_tr_b16 v[104:105], v17 offset:128
    ds_read_b64_tr_b16 v[106:107], v17 offset:1408
    s_add_u32 m0, s75, s71
    s_nop 0
    buffer_load_dwordx4 v11, s[56:59], s73 offen lds
    v_mfma_f32_32x32x16_bf16 v[192:207], v[56:59], v[32:35], v[192:207]
    ds_read_b64_tr_b16 v[108:109], v17 offset:5120
    ds_read_b64_tr_b16 v[110:111], v17 offset:6400
    ds_read_b64_tr_b16 v[112:113], v17 offset:5152
    ds_read_b64_tr_b16 v[114:115], v17 offset:6432
    v_mfma_f32_32x32x16_bf16 v[128:143], v[60:63], v[36:39], v[128:143]
    ds_read_b64_tr_b16 v[116:117], v17 offset:5184
    ds_read_b64_tr_b16 v[118:119], v17 offset:6464
    ds_read_b64_tr_b16 v[120:121], v17 offset:5216
    ds_read_b64_tr_b16 v[122:123], v17 offset:6496
    v_mfma_f32_32x32x16_bf16 v[144:159], v[64:67], v[36:39], v[144:159]
    ds_read_b64_tr_b16 v[124:125], v17 offset:5248
    ds_read_b64_tr_b16 v[126:127], v17 offset:6528
    v_mfma_f32_32x32x16_bf16 v[160:175], v[68:71], v[36:39], v[160:175]
    v_mfma_f32_32x32x16_bf16 v[176:191], v[72:75], v[36:39], v[176:191]
    s_add_u32 s73, s73, 110592
    s_sub_u32 s12, s73, 2211840
    s_cmp_ge_u32 s73, s1
    s_cselect_b32 s73, s12, s73
    s_add_u32 s75, s75, 20544
    s_cmp_ge_u32 s75, 151872
    s_cselect_b32 s75, 49152, s75
    s_cmp_eq_u32 s3, 0
    s_cbranch_scc0 K1_AC_CBFB
    v_readfirstlane_b32 s10, v31
    s_cmp_eq_u32 s10, 255
    s_cbranch_scc0 K1_AC_CBFB
    v_readfirstlane_b32 s10, v247
    s_cmp_lg_u32 s10, 0
    s_cbranch_scc1 K1_EN1_ACCBFB
    v_mov_b32 v3, 0
    s_mov_b32 s11, 30000
K1_EN0_ACCBFB:
    global_load_dword v247, v3, s[44:45] sc1
    s_waitcnt vmcnt(0)
    v_readfirstlane_b32 s10, v247
    s_sub_u32 s11, s11, 1
    s_cmp_eq_u32 s11, 0
    s_cbranch_scc1 K1_EN1_ACCBFB
    s_cmp_eq_u32 s10, 0
    s_cbranch_scc1 K1_EN0_ACCBFB
K1_EN1_ACCBFB:
    s_mov_b32 s11, 32505856
    v_lshlrev_b32 v27, 7, v2
    v_add_u32 v27, s11, v27
    s_mov_b32 exec_hi, 0
    global_store_dword v27, v247, s[46:47] sc1
    s_mov_b64 exec, -1
K1_AC_CBFB:
    v_mfma_f32_32x32x16_bf16 v[192:207], v[76:79], v[36:39], v[192:207]
    s_waitcnt vmcnt(2) lgkmcnt(0)
    s_barrier
    v_mfma_f32_32x32x16_bf16 v[128:143], v[88:91], v[80:83], v[128:143]
    v_add_u32 v15, s78, v13
    v_xor_b32 v16, 32, v15
    v_add_u32 v17, s76, v14
    s_add_u32 s76, s76, 20544
    s_cmp_ge_u32 s76, 151872
    s_cselect_b32 s76, 49152, s76
    v_mfma_f32_32x32x16_bf16 v[144:159], v[92:95], v[80:83], v[144:159]
    ds_read_b128 v[32:35], v15
    ds_read_b128 v[36:39], v16
    ds_read_b64_tr_b16 v[40:41], v17 offset:0
    ds_read_b64_tr_b16 v[42:43], v17 offset:1280
    s_add_u32 m0, s75, s70
    s_nop 0
    buffer_load_dwordx4 v10, s[52:55], s73 offen lds
    v_mfma_f32_32x32x16_bf16 v[160:175], v[96:99], v[80:83], v[160:175]
    ds_read_b64_tr_b16 v[44:45], v17 offset:32
    ds_read_b64_tr_b16 v[46:47], v17 offset:1312
    ds_read_b64_tr_b16 v[48:49], v17 offset:64
    ds_read_b64_tr_b16 v[50:51], v17 offset:1344
    v_mfma_f32_32x32x16_bf16 v[176:191], v[100:103], v[80:83], v[176:191]
    ds_read_b64_tr_b16 v[52:53], v17 offset:96
    ds_read_b64_tr_b16 v[54:55], v17 offset:1376
    ds_read_b64_tr_b16 v[56:57], v17 offset:128
    ds_read_b64_tr_b16 v[58:59], v17 offset:1408
    s_add_u32 m0, s75, s71
    s_nop 0
    buffer_load_dwordx4 v11, s[56:59], s73 offen lds
    v_mfma_f32_32x32x16_bf16 v[192:207], v[104:107], v[80:83], v[192:207]
    ds_read_b64_tr_b16 v[60:61], v17 offset:5120
    ds_read_b64_tr_b16 v[62:63], v17 offset:6400
    ds_read_b64_tr_b16 v[64:65], v17 offset:5152
    ds_read_b64_tr_b16 v[66:67], v17 offset:6432
    v_mfma_f32_32x32x16_bf16 v[128:143], v[108:111], v[84:87], v[128:143]
    ds_read_b64_tr_b16 v[68:69], v17 offset:5184
    ds_read_b64_tr_b16 v[70:71], v17 offset:6464
    ds_read_b64_tr_b16 v[72:73], v17 offset:5216
    ds_read_b64_tr_b16 v[74:75], v17 offset:6496
    v_mfma_f32_32x32x16_bf16 v[144:159], v[112:115], v[84:87], v[144:159]
    ds_read_b64_tr_b16 v[76:77], v17 offset:5248
    ds_read_b64_tr_b16 v[78:79], v17 offset:6528
    v_mfma_f32_32x32x16_bf16 v[160:175], v[116:119], v[84:87], v[160:175]
    v_mfma_f32_32x32x16_bf16 v[176:191], v[120:123], v[84:87], v[176:191]
    s_add_u32 s73, s73, 110592
    s_sub_u32 s12, s73, 2211840
    s_cmp_ge_u32 s73, s1
    s_cselect_b32 s73, s12, s73
    s_add_u32 s75, s75, 20544
    s_cmp_ge_u32 s75, 151872
    s_cselect_b32 s75, 49152, s75
    v_mfma_f32_32x32x16_bf16 v[192:207], v[124:127], v[84:87], v[192:207]
    s_waitcnt lgkmcnt(0)
    v_mfma_f32_32x32x16_bf16 v[128:143], v[40:43], v[32:35], v[128:143]
    v_add_u32 v15, s78, v13
    v_xor_b32 v15, 64, v15
    v_xor_b32 v16, 32, v15
    v_add_u32 v17, s76, v14
    s_add_u32 s76, s76, 20544
    s_cmp_ge_u32 s76, 151872
    s_cselect_b32 s76, 49152, s76
    s_add_u32 s78, s78, 16384
    s_cmp_ge_u32 s78, 49152
    s_cselect_b32 s78, 0, s78
    v_mfma_f32_32x32x16_bf16 v[144:159], v[44:47], v[32:35], v[144:159]
    ds_read_b128 v[80:83], v15
    ds_read_b128 v[84:87], v16
    ds_read_b64_tr_b16 v[88:89], v17 offset:0
    ds_read_b64_tr_b16 v[90:91], v17 offset:1280
    v_mfma_f32_32x32x16_bf16 v[160:175], v[48:51], v[32:35], v[160:175]
    ds_read_b64_tr_b16 v[92:93], v17 offset:32
    ds_read_b64_tr_b16 v[94:95], v17 offset:1312
    ds_read_b64_tr_b16 v[96:97], v17 offset:64
    ds_read_b64_tr_b16 v[98:99], v17 offset:1344
    v_mfma_f32_32x32x16_bf16 v[176:191], v[52:55], v[32:35], v[176:191]
    ds_read_b64_tr_b16 v[100:101], v17 offset:96
    ds_read_b64_tr_b16 v[102:103], v17 offset:1376
    ds_read_b64_tr_b16 v[104:105], v17 offset:128
    ds_read_b64_tr_b16 v[106:107], v17 offset:1408
    v_mfma_f32_32x32x16_bf16 v[192:207], v[56:59], v[32:35], v[192:207]
    ds_read_b64_tr_b16 v[108:109], v17 offset:5120
    ds_read_b64_tr_b16 v[110:111], v17 offset:6400
    ds_read_b64_tr_b16 v[112:113], v17 offset:5152
    ds_read_b64_tr_b16 v[114:115], v17 offset:6432
    v_mfma_f32_32x32x16_bf16 v[128:143], v[60:63], v[36:39], v[128:143]
    ds_read_b64_tr_b16 v[116:117], v17 offset:5184
    ds_read_b64_tr_b16 v[118:119], v17 offset:6464
    ds_read_b64_tr_b16 v[120:121], v17 offset:5216
    ds_read_b64_tr_b16 v[122:123], v17 offset:6496
    v_mfma_f32_32x32x16_bf16 v[144:159], v[64:67], v[36:39], v[144:159]
    ds_read_b64_tr_b16 v[124:125], v17 offset:5248
    ds_read_b64_tr_b16 v[126:127], v17 offset:6528
    v_mfma_f32_32x32x16_bf16 v[160:175], v[68:71], v[36:39], v[160:175]
    v_mfma_f32_32x32x16_bf16 v[176:191], v[72:75], v[36:39], v[176:191]
    s_add_u32 s12, s88, 0
    buffer_load_dwordx2 v[208:209], v29, s[80:83], s12 offen sc1
    s_add_u32 s12, s88, 2560
    buffer_load_dwordx2 v[210:211], v29, s[80:83], s12 offen sc1
    s_add_u32 s12, s88, 5120
    buffer_load_dwordx2 v[212:213], v29, s[80:83], s12 offen sc1
    s_add_u32 s12, s88, 7680
    buffer_load_dwordx2 v[214:215], v29, s[80:83], s12 offen sc1
    s_add_u32 s12, s88, 10240
    buffer_load_dwordx2 v[216:217], v29, s[80:83], s12 offen sc1
    s_add_u32 s12, s88, 12800
    buffer_load_dwordx2 v[218:219], v29, s[80:83], s12 offen sc1
    s_add_u32 s12, s88, 15360
    buffer_load_dwordx2 v[220:221], v29, s[80:83], s12 offen sc1
    s_add_u32 s12, s88, 17920
    buffer_load_dwordx2 v[222:223], v29, s[80:83], s12 offen sc1
    s_add_u32 s12, s88, 20480
    buffer_load_dwordx2 v[224:225], v29, s[80:83], s12 offen sc1
    s_add_u32 s12, s88, 23040
    buffer_load_dwordx2 v[226:227], v29, s[80:83], s12 offen sc1
    buffer_load_dwordx4 v[228:231], v30, s[84:87], 0 offen sc1
    v_mfma_f32_32x32x16_bf16 v[192:207], v[76:79], v[36:39], v[192:207]
    s_waitcnt vmcnt(11) lgkmcnt(0)
    s_barrier
    v_mfma_f32_32x32x16_bf16 v[128:143], v[88:91], v[80:83], v[128:143]
    v_add_u32 v15, s78, v13
    v_xor_b32 v16, 32, v15
    v_add_u32 v17, s76, v14
    s_add_u32 s76, s76, 20544
    s_cmp_ge_u32 s76, 151872
    s_cselect_b32 s76, 49152, s76
    v_mfma_f32_32x32x16_bf16 v[144:159], v[92:95], v[80:83], v[144:159]
    ds_read_b128 v[32:35], v15
    ds_read_b128 v[36:39], v16
    ds_read_b64_tr_b16 v[40:41], v17 offset:0
    ds_read_b64_tr_b16 v[42:43], v17 offset:1280
    v_mfma_f32_32x32x16_bf16 v[160:175], v[96:99], v[80:83], v[160:175]
    ds_read_b64_tr_b16 v[44:45], v17 offset:32
    ds_read_b64_tr_b16 v[46:47], v17 offset:1312
    ds_read_b64_tr_b16 v[48:49], v17 offset:64
    ds_read_b64_tr_b16 v[50:51], v17 offset:1344
    v_mfma_f32_32x32x16_bf16 v[176:191], v[100:103], v[80:83], v[176:191]
    ds_read_b64_tr_b16 v[52:53], v17 offset:96
    ds_read_b64_tr_b16 v[54:55], v17 offset:1376
    ds_read_b64_tr_b16 v[56:57], v17 offset:128
    ds_read_b64_tr_b16 v[58:59], v17 offset:1408
    v_mfma_f32_32x32x16_bf16 v[192:207], v[104:107], v[80:83], v[192:207]
    ds_read_b64_tr_b16 v[60:61], v17 offset:5120
    ds_read_b64_tr_b16 v[62:63], v17 offset:6400
    ds_read_b64_tr_b16 v[64:65], v17 offset:5152
    ds_read_b64_tr_b16 v[66:67], v17 offset:6432
    v_mfma_f32_32x32x16_bf16 v[128:143], v[108:111], v[84:87], v[128:143]
    ds_read_b64_tr_b16 v[68:69], v17 offset:5184
    ds_read_b64_tr_b16 v[70:71], v17 offset:6464
    ds_read_b64_tr_b16 v[72:73], v17 offset:5216
    ds_read_b64_tr_b16 v[74:75], v17 offset:6496
    v_mfma_f32_32x32x16_bf16 v[144:159], v[112:115], v[84:87], v[144:159]
    ds_read_b64_tr_b16 v[76:77], v17 offset:5248
    ds_read_b64_tr_b16 v[78:79], v17 offset:6528
    v_mfma_f32_32x32x16_bf16 v[160:175], v[116:119], v[84:87], v[160:175]
    v_mfma_f32_32x32x16_bf16 v[176:191], v[120:123], v[84:87], v[176:191]
    v_mfma_f32_32x32x16_bf16 v[192:207], v[124:127], v[84:87], v[192:207]
    s_waitcnt lgkmcnt(0)
    v_mfma_f32_32x32x16_bf16 v[128:143], v[40:43], v[32:35], v[128:143]
    v_add_u32 v15, s78, v13
    v_xor_b32 v15, 64, v15
    v_xor_b32 v16, 32, v15
    v_add_u32 v17, s76, v14
    s_add_u32 s76, s76, 20544
    s_cmp_ge_u32 s76, 151872
    s_cselect_b32 s76, 49152, s76
    s_add_u32 s78, s78, 16384
    s_cmp_ge_u32 s78, 49152
    s_cselect_b32 s78, 0, s78
    v_mfma_f32_32x32x16_bf16 v[144:159], v[44:47], v[32:35], v[144:159]
    ds_read_b128 v[80:83], v15
    ds_read_b128 v[84:87], v16
    ds_read_b64_tr_b16 v[88:89], v17 offset:0
    ds_read_b64_tr_b16 v[90:91], v17 offset:1280
    v_mfma_f32_32x32x16_bf16 v[160:175], v[48:51], v[32:35], v[160:175]
    ds_read_b64_tr_b16 v[92:93], v17 offset:32
    ds_read_b64_tr_b16 v[94:95], v17 offset:1312
    ds_read_b64_tr_b16 v[96:97], v17 offset:64
    ds_read_b64_tr_b16 v[98:99], v17 offset:1344
    v_mfma_f32_32x32x16_bf16 v[176:191], v[52:55], v[32:35], v[176:191]
    ds_read_b64_tr_b16 v[100:101], v17 offset:96
    ds_read_b64_tr_b16 v[102:103], v17 offset:1376
    ds_read_b64_tr_b16 v[104:105], v17 offset:128
    ds_read_b64_tr_b16 v[106:107], v17 offset:1408
    v_mfma_f32_32x32x16_bf16 v[192:207], v[56:59], v[32:35], v[192:207]
    ds_read_b64_tr_b16 v[108:109], v17 offset:5120
    ds_read_b64_tr_b16 v[110:111], v17 offset:6400
    ds_read_b64_tr_b16 v[112:113], v17 offset:5152
    ds_read_b64_tr_b16 v[114:115], v17 offset:6432
    v_mfma_f32_32x32x16_bf16 v[128:143], v[60:63], v[36:39], v[128:143]
    ds_read_b64_tr_b16 v[116:117], v17 offset:5184
    ds_read_b64_tr_b16 v[118:119], v17 offset:6464
    ds_read_b64_tr_b16 v[120:121], v17 offset:5216
    ds_read_b64_tr_b16 v[122:123], v17 offset:6496
    v_mfma_f32_32x32x16_bf16 v[144:159], v[64:67], v[36:39], v[144:159]
    ds_read_b64_tr_b16 v[124:125], v17 offset:5248
    ds_read_b64_tr_b16 v[126:127], v17 offset:6528
    v_mfma_f32_32x32x16_bf16 v[160:175], v[68:71], v[36:39], v[160:175]
    v_mfma_f32_32x32x16_bf16 v[176:191], v[72:75], v[36:39], v[176:191]
    v_readfirstlane_b32 s10, v247
    s_cmp_lg_u32 s10, 0
    s_cbranch_scc1 K1_EN1_FEB
    v_mov_b32 v3, 0
    s_mov_b32 s11, 30000
K1_EN0_FEB:
    global_load_dword v247, v3, s[44:45] sc1
    s_waitcnt vmcnt(0)
    v_readfirstlane_b32 s10, v247
    s_sub_u32 s11, s11, 1
    s_cmp_eq_u32 s11, 0
    s_cbranch_scc1 K1_EN1_FEB
    s_cmp_eq_u32 s10, 0
    s_cbranch_scc1 K1_EN0_FEB
K1_EN1_FEB:
    s_mov_b32 s77, 30000
K1F_CHKB:
    s_waitcnt vmcnt(0)
    v_not_b32 v3, v247
    v_cmp_eq_u32 s[10:11], v230, v247
    v_cmp_eq_u32 vcc, v231, v3
    s_and_b64 s[10:11], s[10:11], vcc
    v_mov_b32 v4, 0x7ffffff0
    v_cmp_eq_u32 s[12:13], v4, v29
    s_mov_b64 s[14:15], -1
    v_cmp_eq_u32 vcc, v209, v247
    s_and_b64 s[14:15], s[14:15], vcc
    v_cmp_eq_u32 vcc, v211, v247
    s_and_b64 s[14:15], s[14:15], vcc
    v_cmp_eq_u32 vcc, v213, v247
    s_and_b64 s[14:15], s[14:15], vcc
    v_cmp_eq_u32 vcc, v215, v247
    s_and_b64 s[14:15], s[14:15], vcc
    v_cmp_eq_u32 vcc, v217, v247
    s_and_b64 s[14:15], s[14:15], vcc
    v_cmp_eq_u32 vcc, v219, v247
    s_and_b64 s[14:15], s[14:15], vcc
    v_cmp_eq_u32 vcc, v221, v247
    s_and_b64 s[14:15], s[14:15], vcc
    v_cmp_eq_u32 vcc, v223, v247
    s_and_b64 s[14:15], s[14:15], vcc
    v_cmp_eq_u32 vcc, v225, v247
    s_and_b64 s[14:15], s[14:15], vcc
    v_cmp_eq_u32 vcc, v227, v247
    s_and_b64 s[14:15], s[14:15], vcc
    s_or_b64 s[14:15], s[14:15], s[12:13]
    s_and_b64 s[10:11], s[10:11], s[14:15]
    s_cmp_eq_u64 s[10:11], -1
    s_cbranch_scc1 K1F_OKB
    s_sub_u32 s77, s77, 1
    s_cmp_eq_u32 s77, 0
    s_cbranch_scc1 K1F_OKB
    s_sleep 1
    s_add_u32 s12, s88, 0
    buffer_load_dwordx2 v[208:209], v29, s[80:83], s12 offen sc1
    s_add_u32 s12, s88, 2560
    buffer_load_dwordx2 v[210:211], v29, s[80:83], s12 offen sc1
    s_add_u32 s12, s88, 5120
    buffer_load_dwordx2 v[212:213], v29, s[80:83], s12 offen sc1
    s_add_u32 s12, s88, 7680
    buffer_load_dwordx2 v[214:215], v29, s[80:83], s12 offen sc1
    s_add_u32 s12, s88, 10240
    buffer_load_dwordx2 v[216:217], v29, s[80:83], s12 offen sc1
    s_add_u32 s12, s88, 12800
    buffer_load_dwordx2 v[218:219], v29, s[80:83], s12 offen sc1
    s_add_u32 s12, s88, 15360
    buffer_load_dwordx2 v[220:221], v29, s[80:83], s12 offen sc1
    s_add_u32 s12, s88, 17920
    buffer_load_dwordx2 v[222:223], v29, s[80:83], s12 offen sc1
    s_add_u32 s12, s88, 20480
    buffer_load_dwordx2 v[224:225], v29, s[80:83], s12 offen sc1
    s_add_u32 s12, s88, 23040
    buffer_load_dwordx2 v[226:227], v29, s[80:83], s12 offen sc1
    buffer_load_dwordx4 v[228:231], v30, s[84:87], 0 offen sc1
    s_branch K1F_CHKB
K1F_OKB:
    v_add_f32 v208, v208, v210
    v_add_f32 v208, v208, v212
    v_add_f32 v208, v208, v214
    v_add_f32 v208, v208, v216
    v_add_f32 v208, v208, v218
    v_add_f32 v208, v208, v220
    v_add_f32 v208, v208, v222
    v_add_f32 v208, v208, v224
    v_add_f32 v208, v208, v226
    v_lshlrev_b32 v4, 2, v0
    v_cmp_gt_u32 vcc, 320, v0
    s_and_saveexec_b64 s[10:11], vcc
    v_add_u32 v4, 162112, v4
    ds_write_b32 v4, v208
    s_mov_b64 exec, s[10:11]
    s_lshr_b32 s10, s2, 3
    s_lshl_b32 s10, s10, 7
    s_add_u32 s10, s10, 32505856
    v_mov_b32 v1, s10
    global_load_dword v1, v1, s[46:47] sc1
    v_mfma_f32_32x32x16_bf16 v[192:207], v[76:79], v[36:39], v[192:207]
    s_waitcnt lgkmcnt(0)
    v_mfma_f32_32x32x16_bf16 v[128:143], v[88:91], v[80:83], v[128:143]
    v_mfma_f32_32x32x16_bf16 v[144:159], v[92:95], v[80:83], v[144:159]
    v_mfma_f32_32x32x16_bf16 v[160:175], v[96:99], v[80:83], v[160:175]
    v_mfma_f32_32x32x16_bf16 v[176:191], v[100:103], v[80:83], v[176:191]
    v_mfma_f32_32x32x16_bf16 v[192:207], v[104:107], v[80:83], v[192:207]
    v_mfma_f32_32x32x16_bf16 v[128:143], v[108:111], v[84:87], v[128:143]
    v_mfma_f32_32x32x16_bf16 v[144:159], v[112:115], v[84:87], v[144:159]
    v_mfma_f32_32x32x16_bf16 v[160:175], v[116:119], v[84:87], v[160:175]
    v_mfma_f32_32x32x16_bf16 v[176:191], v[120:123], v[84:87], v[176:191]
    v_mfma_f32_32x32x16_bf16 v[192:207], v[124:127], v[84:87], v[192:207]
    s_branch K1F_EPI
HK_FB_I:
    s_cmp_lg_u32 s91, 0
    s_cselect_b32 s92, s28, s26
    s_cselect_b32 s93, s29, s27
    s_mov_b32 s94, 819200
    s_mov_b32 s95, 0x20000
    buffer_load_dwordx4 v[248:251], v232, s[92:95], s89 offen
    s_mul_i32 s13, s6, 11
    s_add_u32 s13, s13, s7
    s_cmp_ge_u32 s13, 24
    s_cbranch_scc1 K1_NOC_13
    s_cmp_lg_u32 s14, 0
    s_cselect_b32 s92, s28, s26
    s_cselect_b32 s93, s29, s27
    s_mov_b32 s94, 819200
    s_mov_b32 s95, 0x20000
    buffer_load_dwordx4 v[240:243], v244, s[92:95], s8 offen
K1_NOC_13:
    s_sub_u32 s13, s3, 1
    s_cmp_ge_u32 s13, 2
    s_cbranch_scc1 K1_NOW_14
    s_mov_b32 s92, s40
    s_mov_b32 s93, s41
    s_mov_b32 s94, 2211840
    s_mov_b32 s95, 0x20000
    s_mul_i32 s13, s13, 5120
    s_add_u32 s13, s13, 151872
    s_add_u32 m0, s13, 0
    s_nop 0
    buffer_load_dwordx4 v233, s[92:95], s90 offen lds
    s_add_u32 m0, s13, 1024
    s_nop 0
    buffer_load_dwordx4 v234, s[92:95], s90 offen lds
    s_add_u32 m0, s13, 2048
    s_nop 0
    buffer_load_dwordx4 v235, s[92:95], s90 offen lds
    s_add_u32 m0, s13, 3072
    s_nop 0
    buffer_load_dwordx4 v236, s[92:95], s90 offen lds
    s_add_u32 m0, s13, 4096
    s_nop 0
    buffer_load_dwordx4 v237, s[92:95], s90 offen lds
K1_NOW_14:
    s_branch HK_FB_I_B
HK_FB_F:
    v_lshlrev_b32 v228, 4, v2
    v_and_b32 v4, 15, v2
    v_lshlrev_b32 v4, 4, v4
    v_lshrrev_b32 v3, 4, v2
    v_lshl_add_u32 v4, v3, 2, v4
    ds_bpermute_b32 v208, v4, v248
    ds_bpermute_b32 v209, v4, v249
    ds_bpermute_b32 v210, v4, v250
    ds_bpermute_b32 v211, v4, v251
    ds_bpermute_b32 v212, v4, v240
    ds_bpermute_b32 v213, v4, v241
    ds_bpermute_b32 v214, v4, v242
    ds_bpermute_b32 v215, v4, v243
    s_waitcnt lgkmcnt(0)
    buffer_store_dwordx4 v[208:211], v228, s[96:99], s100 offen sc1
    s_mul_i32 s13, s6, 11
    s_add_u32 s13, s13, s7
    s_cmp_ge_u32 s13, 24
    s_cbranch_scc1 K1_SF1_15
    buffer_store_dwordx4 v[212:215], v228, s[96:99], s9 offen sc1
K1_SF1_15:
    s_nop 1
    s_sub_u32 s13, s3, 1
    s_cmp_ge_u32 s13, 2
    s_cbranch_scc1 K1_SF2_16
    v_lshrrev_b32 v229, 5, v2
    v_lshlrev_b32 v229, 4, v229
    v_bfe_u32 v4, v2, 4, 1
    v_lshl_add_u32 v229, v4, 2, v229
    v_bfe_u32 v4, v2, 2, 2
    v_add_u32 v229, v229, v4
    v_mul_u32_u24 v229, 160, v229
    v_and_b32 v4, 3, v2
    v_lshl_add_u32 v229, v4, 3, v229
    s_mul_i32 s13, s13, 5120
    s_add_u32 s13, s13, 151872
    v_add_u32 v229, s13, v229
    ds_read_b64_tr_b16 v[208:209], v229 offset:0
    ds_read_b64_tr_b16 v[210:211], v229 offset:1280
    ds_read_b64_tr_b16 v[212:213], v229 offset:32
    ds_read_b64_tr_b16 v[214:215], v229 offset:1312
    ds_read_b64_tr_b16 v[216:217], v229 offset:64
    ds_read_b64_tr_b16 v[218:219], v229 offset:1344
    ds_read_b64_tr_b16 v[220:221], v229 offset:96
    ds_read_b64_tr_b16 v[222:223], v229 offset:1376
    ds_read_b64_tr_b16 v[224:225], v229 offset:128
    ds_read_b64_tr_b16 v[226:227], v229 offset:1408
    s_waitcnt lgkmcnt(0)
    s_add_u32 s13, s101, 0
    buffer_store_dwordx4 v[208:211], v228, s[96:99], s13 offen sc1
    s_add_u32 s13, s101, 1024
    buffer_store_dwordx4 v[212:215], v228, s[96:99], s13 offen sc1
    s_add_u32 s13, s101, 2048
    buffer_store_dwordx4 v[216:219], v228, s[96:99], s13 offen sc1
    s_add_u32 s13, s101, 3072
    buffer_store_dwordx4 v[220:223], v228, s[96:99], s13 offen sc1
    s_add_u32 s13, s101, 4096
    buffer_store_dwordx4 v[224:227], v228, s[96:99], s13 offen sc1
K1_SF2_16:
    s_branch HK_FB_F_B
HK_FB_A:
    s_cmp_eq_u32 s3, 0
    s_cbranch_scc0 K1_AI_CBFB
    s_mov_b32 s10, 32
    v_mov_b32 v31, s10
    v_mov_b32 v27, 1
    s_mov_b64 s[12:13], exec
    s_mov_b64 exec, 1
    global_atomic_add v31, v31, v27, s[44:45] sc0 sc1
    s_mov_b64 exec, s[12:13]
K1_AI_CBFB:
    s_branch HK_FB_A_B
K1F_EPI:
    s_setprio 0
    s_waitcnt vmcnt(0) lgkmcnt(0)
    v_readfirstlane_b32 s70, v1
    s_barrier
    v_lshrrev_b32 v4, 5, v2
    v_lshlrev_b32 v4, 4, v4
    s_mul_i32 s12, s5, 640
    s_add_u32 s12, s12, 162112
    v_add_u32 v4, s12, v4
    ds_read_b128 v[48:51], v4 offset:0
    ds_read_b128 v[52:55], v4 offset:32
    ds_read_b128 v[56:59], v4 offset:64
    ds_read_b128 v[60:63], v4 offset:96
    ds_read_b128 v[64:67], v4 offset:128
    ds_read_b128 v[68:71], v4 offset:160
    ds_read_b128 v[72:75], v4 offset:192
    ds_read_b128 v[76:79], v4 offset:224
    ds_read_b128 v[80:83], v4 offset:256
    ds_read_b128 v[84:87], v4 offset:288
    ds_read_b128 v[88:91], v4 offset:320
    ds_read_b128 v[92:95], v4 offset:352
    ds_read_b128 v[96:99], v4 offset:384
    ds_read_b128 v[100:103], v4 offset:416
    ds_read_b128 v[104:107], v4 offset:448
    ds_read_b128 v[108:111], v4 offset:480
    ds_read_b128 v[112:115], v4 offset:512
    ds_read_b128 v[116:119], v4 offset:544
    ds_read_b128 v[120:123], v4 offset:576
    ds_read_b128 v[124:127], v4 offset:608
    v_mov_b32 v20, v228
    v_mov_b32 v22, v229
    v_rcp_f32 v26, v229
    s_and_b32 s10, s4, 1
    s_lshl_b32 s10, s10, 11
    v_bfe_u32 v3, v2, 4, 1
    v_lshlrev_b32 v3, 10, v3
    v_and_b32 v4, 15, v2
    v_lshl_add_u32 v3, v4, 4, v3
    v_lshrrev_b32 v4, 5, v2
    v_lshl_add_u32 v3, v4, 8, v3
    v_add_u32 v3, s10, v3
    s_lshl_b32 s10, s6, 1
    s_lshr_b32 s11, s4, 1
    s_add_u32 s10, s10, s11
    s_mul_i32 s10, s10, 94
    s_add_u32 s10, s10, 40
    s_mul_i32 s11, s7, 10
    s_mul_i32 s12, s5, 5
    s_add_u32 s11, s11, s12
    s_mov_b32 s52, 0xbdd2d3e8
    s_mov_b32 s53, 0xbdd2d3e8
    v_mov_b32 v24, 0xc0135761
    s_waitcnt lgkmcnt(15)
    s_add_u32 s12, s11, 0
    s_cmp_ge_u32 s12, 108
    s_cbranch_scc1 K1FS_17
    v_pk_fma_f32 v[128:129], v[20:21], v[48:49], v[128:129] op_sel_hi:[0,1,1] neg_lo:[1,0,0] neg_hi:[1,0,0]
    v_pk_fma_f32 v[130:131], v[20:21], v[50:51], v[130:131] op_sel_hi:[0,1,1] neg_lo:[1,0,0] neg_hi:[1,0,0]
    v_pk_fma_f32 v[132:133], v[20:21], v[52:53], v[132:133] op_sel_hi:[0,1,1] neg_lo:[1,0,0] neg_hi:[1,0,0]
    v_pk_fma_f32 v[134:135], v[20:21], v[54:55], v[134:135] op_sel_hi:[0,1,1] neg_lo:[1,0,0] neg_hi:[1,0,0]
    v_pk_fma_f32 v[136:137], v[20:21], v[56:57], v[136:137] op_sel_hi:[0,1,1] neg_lo:[1,0,0] neg_hi:[1,0,0]
    v_pk_fma_f32 v[138:139], v[20:21], v[58:59], v[138:139] op_sel_hi:[0,1,1] neg_lo:[1,0,0] neg_hi:[1,0,0]
    v_pk_fma_f32 v[140:141], v[20:21], v[60:61], v[140:141] op_sel_hi:[0,1,1] neg_lo:[1,0,0] neg_hi:[1,0,0]
    v_pk_fma_f32 v[142:143], v[20:21], v[62:63], v[142:143] op_sel_hi:[0,1,1] neg_lo:[1,0,0] neg_hi:[1,0,0]
    v_pk_mul_f32 v[128:129], v[128:129], v[22:23] op_sel_hi:[1,0]
    v_pk_mul_f32 v[130:131], v[130:131], v[22:23] op_sel_hi:[1,0]
    v_pk_mul_f32 v[132:133], v[132:133], v[22:23] op_sel_hi:[1,0]
    v_pk_mul_f32 v[134:135], v[134:135], v[22:23] op_sel_hi:[1,0]
    v_pk_mul_f32 v[32:33], v[128:129], v[128:129]
    v_pk_mul_f32 v[34:35], v[130:131], v[130:131]
    v_pk_mul_f32 v[36:37], v[132:133], v[132:133]
    v_pk_mul_f32 v[38:39], v[134:135], v[134:135]
    v_pk_fma_f32 v[32:33], v[32:33], s[52:53], v[24:25] op_sel_hi:[1,1,0]
    v_pk_fma_f32 v[34:35], v[34:35], s[52:53], v[24:25] op_sel_hi:[1,1,0]
    v_pk_fma_f32 v[36:37], v[36:37], s[52:53], v[24:25] op_sel_hi:[1,1,0]
    v_pk_fma_f32 v[38:39], v[38:39], s[52:53], v[24:25] op_sel_hi:[1,1,0]
    v_pk_mul_f32 v[32:33], v[32:33], v[128:129]
    v_pk_mul_f32 v[34:35], v[34:35], v[130:131]
    v_pk_mul_f32 v[36:37], v[36:37], v[132:133]
    v_pk_mul_f32 v[38:39], v[38:39], v[134:135]
    v_exp_f32 v32, v32
    v_exp_f32 v33, v33
    v_exp_f32 v34, v34
    v_exp_f32 v35, v35
    v_exp_f32 v36, v36
    v_exp_f32 v37, v37
    v_exp_f32 v38, v38
    v_exp_f32 v39, v39
    v_pk_mul_f32 v[136:137], v[128:129], v[136:137]
    v_pk_mul_f32 v[138:139], v[130:131], v[138:139]
    v_pk_mul_f32 v[140:141], v[132:133], v[140:141]
    v_pk_mul_f32 v[142:143], v[134:135], v[142:143]
    v_pk_fma_f32 v[32:33], v[32:33], v[26:27], v[26:27] op_sel_hi:[1,0,0]
    v_pk_fma_f32 v[34:35], v[34:35], v[26:27], v[26:27] op_sel_hi:[1,0,0]
    v_pk_fma_f32 v[36:37], v[36:37], v[26:27], v[26:27] op_sel_hi:[1,0,0]
    v_pk_fma_f32 v[38:39], v[38:39], v[26:27], v[26:27] op_sel_hi:[1,0,0]
    v_rcp_f32 v32, v32
    v_rcp_f32 v33, v33
    v_rcp_f32 v34, v34
    v_rcp_f32 v35, v35
    v_rcp_f32 v36, v36
    v_rcp_f32 v37, v37
    v_rcp_f32 v38, v38
    v_rcp_f32 v39, v39
    s_lshr_b32 s13, s12, 1
    s_add_u32 s13, s13, s10
    v_pk_mul_f32 v[136:137], v[136:137], v[32:33]
    v_pk_mul_f32 v[138:139], v[138:139], v[34:35]
    v_pk_mul_f32 v[140:141], v[140:141], v[36:37]
    v_pk_mul_f32 v[142:143], v[142:143], v[38:39]
    s_lshl_b32 s13, s13, 12
    s_and_b32 s12, s12, 1
    v_cvt_pk_bf16_f32 v40, v136, v137
    v_cvt_pk_bf16_f32 v41, v138, v139
    v_cvt_pk_bf16_f32 v42, v140, v141
    v_cvt_pk_bf16_f32 v43, v142, v143
    s_lshl_b32 s12, s12, 9
    s_add_u32 s13, s13, s12
    buffer_store_dwordx4 v[40:43], v3, s[64:67], s13 offen sc1
K1FS_17:
    s_waitcnt lgkmcnt(12)
    s_add_u32 s12, s11, 1
    s_cmp_ge_u32 s12, 108
    s_cbranch_scc1 K1FS_18
    v_pk_fma_f32 v[144:145], v[20:21], v[64:65], v[144:145] op_sel_hi:[0,1,1] neg_lo:[1,0,0] neg_hi:[1,0,0]
    v_pk_fma_f32 v[146:147], v[20:21], v[66:67], v[146:147] op_sel_hi:[0,1,1] neg_lo:[1,0,0] neg_hi:[1,0,0]
    v_pk_fma_f32 v[148:149], v[20:21], v[68:69], v[148:149] op_sel_hi:[0,1,1] neg_lo:[1,0,0] neg_hi:[1,0,0]
    v_pk_fma_f32 v[150:151], v[20:21], v[70:71], v[150:151] op_sel_hi:[0,1,1] neg_lo:[1,0,0] neg_hi:[1,0,0]
    v_pk_fma_f32 v[152:153], v[20:21], v[72:73], v[152:153] op_sel_hi:[0,1,1] neg_lo:[1,0,0] neg_hi:[1,0,0]
    v_pk_fma_f32 v[154:155], v[20:21], v[74:75], v[154:155] op_sel_hi:[0,1,1] neg_lo:[1,0,0] neg_hi:[1,0,0]
    v_pk_fma_f32 v[156:157], v[20:21], v[76:77], v[156:157] op_sel_hi:[0,1,1] neg_lo:[1,0,0] neg_hi:[1,0,0]
    v_pk_fma_f32 v[158:159], v[20:21], v[78:79], v[158:159] op_sel_hi:[0,1,1] neg_lo:[1,0,0] neg_hi:[1,0,0]
    v_pk_mul_f32 v[144:145], v[144:145], v[22:23] op_sel_hi:[1,0]
    v_pk_mul_f32 v[146:147], v[146:147], v[22:23] op_sel_hi:[1,0]
    v_pk_mul_f32 v[148:149], v[148:149], v[22:23] op_sel_hi:[1,0]
    v_pk_mul_f32 v[150:151], v[150:151], v[22:23] op_sel_hi:[1,0]
    v_pk_mul_f32 v[32:33], v[144:145], v[144:145]
    v_pk_mul_f32 v[34:35], v[146:147], v[146:147]
    v_pk_mul_f32 v[36:37], v[148:149], v[148:149]
    v_pk_mul_f32 v[38:39], v[150:151], v[150:151]
    v_pk_fma_f32 v[32:33], v[32:33], s[52:53], v[24:25] op_sel_hi:[1,1,0]
    v_pk_fma_f32 v[34:35], v[34:35], s[52:53], v[24:25] op_sel_hi:[1,1,0]
    v_pk_fma_f32 v[36:37], v[36:37], s[52:53], v[24:25] op_sel_hi:[1,1,0]
    v_pk_fma_f32 v[38:39], v[38:39], s[52:53], v[24:25] op_sel_hi:[1,1,0]
    v_pk_mul_f32 v[32:33], v[32:33], v[144:145]
    v_pk_mul_f32 v[34:35], v[34:35], v[146:147]
    v_pk_mul_f32 v[36:37], v[36:37], v[148:149]
    v_pk_mul_f32 v[38:39], v[38:39], v[150:151]
    v_exp_f32 v32, v32
    v_exp_f32 v33, v33
    v_exp_f32 v34, v34
    v_exp_f32 v35, v35
    v_exp_f32 v36, v36
    v_exp_f32 v37, v37
    v_exp_f32 v38, v38
    v_exp_f32 v39, v39
    v_pk_mul_f32 v[152:153], v[144:145], v[152:153]
    v_pk_mul_f32 v[154:155], v[146:147], v[154:155]
    v_pk_mul_f32 v[156:157], v[148:149], v[156:157]
    v_pk_mul_f32 v[158:159], v[150:151], v[158:159]
    v_pk_fma_f32 v[32:33], v[32:33], v[26:27], v[26:27] op_sel_hi:[1,0,0]
    v_pk_fma_f32 v[34:35], v[34:35], v[26:27], v[26:27] op_sel_hi:[1,0,0]
    v_pk_fma_f32 v[36:37], v[36:37], v[26:27], v[26:27] op_sel_hi:[1,0,0]
    v_pk_fma_f32 v[38:39], v[38:39], v[26:27], v[26:27] op_sel_hi:[1,0,0]
    v_rcp_f32 v32, v32
    v_rcp_f32 v33, v33
    v_rcp_f32 v34, v34
    v_rcp_f32 v35, v35
    v_rcp_f32 v36, v36
    v_rcp_f32 v37, v37
    v_rcp_f32 v38, v38
    v_rcp_f32 v39, v39
    s_lshr_b32 s13, s12, 1
    s_add_u32 s13, s13, s10
    v_pk_mul_f32 v[152:153], v[152:153], v[32:33]
    v_pk_mul_f32 v[154:155], v[154:155], v[34:35]
    v_pk_mul_f32 v[156:157], v[156:157], v[36:37]
    v_pk_mul_f32 v[158:159], v[158:159], v[38:39]
    s_lshl_b32 s13, s13, 12
    s_and_b32 s12, s12, 1
    v_cvt_pk_bf16_f32 v44, v152, v153
    v_cvt_pk_bf16_f32 v45, v154, v155
    v_cvt_pk_bf16_f32 v46, v156, v157
    v_cvt_pk_bf16_f32 v47, v158, v159
    s_lshl_b32 s12, s12, 9
    s_add_u32 s13, s13, s12
    buffer_store_dwordx4 v[44:47], v3, s[64:67], s13 offen sc1
K1FS_18:
    s_waitcnt lgkmcnt(8)
    s_add_u32 s12, s11, 2
    s_cmp_ge_u32 s12, 108
    s_cbranch_scc1 K1FS_19
    v_pk_fma_f32 v[160:161], v[20:21], v[80:81], v[160:161] op_sel_hi:[0,1,1] neg_lo:[1,0,0] neg_hi:[1,0,0]
    v_pk_fma_f32 v[162:163], v[20:21], v[82:83], v[162:163] op_sel_hi:[0,1,1] neg_lo:[1,0,0] neg_hi:[1,0,0]
    v_pk_fma_f32 v[164:165], v[20:21], v[84:85], v[164:165] op_sel_hi:[0,1,1] neg_lo:[1,0,0] neg_hi:[1,0,0]
    v_pk_fma_f32 v[166:167], v[20:21], v[86:87], v[166:167] op_sel_hi:[0,1,1] neg_lo:[1,0,0] neg_hi:[1,0,0]
    v_pk_fma_f32 v[168:169], v[20:21], v[88:89], v[168:169] op_sel_hi:[0,1,1] neg_lo:[1,0,0] neg_hi:[1,0,0]
    v_pk_fma_f32 v[170:171], v[20:21], v[90:91], v[170:171] op_sel_hi:[0,1,1] neg_lo:[1,0,0] neg_hi:[1,0,0]
    v_pk_fma_f32 v[172:173], v[20:21], v[92:93], v[172:173] op_sel_hi:[0,1,1] neg_lo:[1,0,0] neg_hi:[1,0,0]
    v_pk_fma_f32 v[174:175], v[20:21], v[94:95], v[174:175] op_sel_hi:[0,1,1] neg_lo:[1,0,0] neg_hi:[1,0,0]
    v_pk_mul_f32 v[160:161], v[160:161], v[22:23] op_sel_hi:[1,0]
    v_pk_mul_f32 v[162:163], v[162:163], v[22:23] op_sel_hi:[1,0]
    v_pk_mul_f32 v[164:165], v[164:165], v[22:23] op_sel_hi:[1,0]
    v_pk_mul_f32 v[166:167], v[166:167], v[22:23] op_sel_hi:[1,0]
    v_pk_mul_f32 v[32:33], v[160:161], v[160:161]
    v_pk_mul_f32 v[34:35], v[162:163], v[162:163]
    v_pk_mul_f32 v[36:37], v[164:165], v[164:165]
    v_pk_mul_f32 v[38:39], v[166:167], v[166:167]
    v_pk_fma_f32 v[32:33], v[32:33], s[52:53], v[24:25] op_sel_hi:[1,1,0]
    v_pk_fma_f32 v[34:35], v[34:35], s[52:53], v[24:25] op_sel_hi:[1,1,0]
    v_pk_fma_f32 v[36:37], v[36:37], s[52:53], v[24:25] op_sel_hi:[1,1,0]
    v_pk_fma_f32 v[38:39], v[38:39], s[52:53], v[24:25] op_sel_hi:[1,1,0]
    v_pk_mul_f32 v[32:33], v[32:33], v[160:161]
    v_pk_mul_f32 v[34:35], v[34:35], v[162:163]
    v_pk_mul_f32 v[36:37], v[36:37], v[164:165]
    v_pk_mul_f32 v[38:39], v[38:39], v[166:167]
    v_exp_f32 v32, v32
    v_exp_f32 v33, v33
    v_exp_f32 v34, v34
    v_exp_f32 v35, v35
    v_exp_f32 v36, v36
    v_exp_f32 v37, v37
    v_exp_f32 v38, v38
    v_exp_f32 v39, v39
    v_pk_mul_f32 v[168:169], v[160:161], v[168:169]
    v_pk_mul_f32 v[170:171], v[162:163], v[170:171]
    v_pk_mul_f32 v[172:173], v[164:165], v[172:173]
    v_pk_mul_f32 v[174:175], v[166:167], v[174:175]
    v_pk_fma_f32 v[32:33], v[32:33], v[26:27], v[26:27] op_sel_hi:[1,0,0]
    v_pk_fma_f32 v[34:35], v[34:35], v[26:27], v[26:27] op_sel_hi:[1,0,0]
    v_pk_fma_f32 v[36:37], v[36:37], v[26:27], v[26:27] op_sel_hi:[1,0,0]
    v_pk_fma_f32 v[38:39], v[38:39], v[26:27], v[26:27] op_sel_hi:[1,0,0]
    v_rcp_f32 v32, v32
    v_rcp_f32 v33, v33
    v_rcp_f32 v34, v34
    v_rcp_f32 v35, v35
    v_rcp_f32 v36, v36
    v_rcp_f32 v37, v37
    v_rcp_f32 v38, v38
    v_rcp_f32 v39, v39
    s_lshr_b32 s13, s12, 1
    s_add_u32 s13, s13, s10
    v_pk_mul_f32 v[168:169], v[168:169], v[32:33]
    v_pk_mul_f32 v[170:171], v[170:171], v[34:35]
    v_pk_mul_f32 v[172:173], v[172:173], v[36:37]
    v_pk_mul_f32 v[174:175], v[174:175], v[38:39]
    s_lshl_b32 s13, s13, 12
    s_and_b32 s12, s12, 1
    v_cvt_pk_bf16_f32 v40, v168, v169
    v_cvt_pk_bf16_f32 v41, v170, v171
    v_cvt_pk_bf16_f32 v42, v172, v173
    v_cvt_pk_bf16_f32 v43, v174, v175
    s_lshl_b32 s12, s12, 9
    s_add_u32 s13, s13, s12
    buffer_store_dwordx4 v[40:43], v3, s[64:67], s13 offen sc1
K1FS_19:
    s_waitcnt lgkmcnt(4)
    s_add_u32 s12, s11, 3
    s_cmp_ge_u32 s12, 108
    s_cbranch_scc1 K1FS_20
    v_pk_fma_f32 v[176:177], v[20:21], v[96:97], v[176:177] op_sel_hi:[0,1,1] neg_lo:[1,0,0] neg_hi:[1,0,0]
    v_pk_fma_f32 v[178:179], v[20:21], v[98:99], v[178:179] op_sel_hi:[0,1,1] neg_lo:[1,0,0] neg_hi:[1,0,0]
    v_pk_fma_f32 v[180:181], v[20:21], v[100:101], v[180:181] op_sel_hi:[0,1,1] neg_lo:[1,0,0] neg_hi:[1,0,0]
    v_pk_fma_f32 v[182:183], v[20:21], v[102:103], v[182:183] op_sel_hi:[0,1,1] neg_lo:[1,0,0] neg_hi:[1,0,0]
    v_pk_fma_f32 v[184:185], v[20:21], v[104:105], v[184:185] op_sel_hi:[0,1,1] neg_lo:[1,0,0] neg_hi:[1,0,0]
    v_pk_fma_f32 v[186:187], v[20:21], v[106:107], v[186:187] op_sel_hi:[0,1,1] neg_lo:[1,0,0] neg_hi:[1,0,0]
    v_pk_fma_f32 v[188:189], v[20:21], v[108:109], v[188:189] op_sel_hi:[0,1,1] neg_lo:[1,0,0] neg_hi:[1,0,0]
    v_pk_fma_f32 v[190:191], v[20:21], v[110:111], v[190:191] op_sel_hi:[0,1,1] neg_lo:[1,0,0] neg_hi:[1,0,0]
    v_pk_mul_f32 v[176:177], v[176:177], v[22:23] op_sel_hi:[1,0]
    v_pk_mul_f32 v[178:179], v[178:179], v[22:23] op_sel_hi:[1,0]
    v_pk_mul_f32 v[180:181], v[180:181], v[22:23] op_sel_hi:[1,0]
    v_pk_mul_f32 v[182:183], v[182:183], v[22:23] op_sel_hi:[1,0]
    v_pk_mul_f32 v[32:33], v[176:177], v[176:177]
    v_pk_mul_f32 v[34:35], v[178:179], v[178:179]
    v_pk_mul_f32 v[36:37], v[180:181], v[180:181]
    v_pk_mul_f32 v[38:39], v[182:183], v[182:183]
    v_pk_fma_f32 v[32:33], v[32:33], s[52:53], v[24:25] op_sel_hi:[1,1,0]
    v_pk_fma_f32 v[34:35], v[34:35], s[52:53], v[24:25] op_sel_hi:[1,1,0]
    v_pk_fma_f32 v[36:37], v[36:37], s[52:53], v[24:25] op_sel_hi:[1,1,0]
    v_pk_fma_f32 v[38:39], v[38:39], s[52:53], v[24:25] op_sel_hi:[1,1,0]
    v_pk_mul_f32 v[32:33], v[32:33], v[176:177]
    v_pk_mul_f32 v[34:35], v[34:35], v[178:179]
    v_pk_mul_f32 v[36:37], v[36:37], v[180:181]
    v_pk_mul_f32 v[38:39], v[38:39], v[182:183]
    v_exp_f32 v32, v32
    v_exp_f32 v33, v33
    v_exp_f32 v34, v34
    v_exp_f32 v35, v35
    v_exp_f32 v36, v36
    v_exp_f32 v37, v37
    v_exp_f32 v38, v38
    v_exp_f32 v39, v39
    v_pk_mul_f32 v[184:185], v[176:177], v[184:185]
    v_pk_mul_f32 v[186:187], v[178:179], v[186:187]
    v_pk_mul_f32 v[188:189], v[180:181], v[188:189]
    v_pk_mul_f32 v[190:191], v[182:183], v[190:191]
    v_pk_fma_f32 v[32:33], v[32:33], v[26:27], v[26:27] op_sel_hi:[1,0,0]
    v_pk_fma_f32 v[34:35], v[34:35], v[26:27], v[26:27] op_sel_hi:[1,0,0]
    v_pk_fma_f32 v[36:37], v[36:37], v[26:27], v[26:27] op_sel_hi:[1,0,0]
    v_pk_fma_f32 v[38:39], v[38:39], v[26:27], v[26:27] op_sel_hi:[1,0,0]
    v_rcp_f32 v32, v32
    v_rcp_f32 v33, v33
    v_rcp_f32 v34, v34
    v_rcp_f32 v35, v35
    v_rcp_f32 v36, v36
    v_rcp_f32 v37, v37
    v_rcp_f32 v38, v38
    v_rcp_f32 v39, v39
    s_lshr_b32 s13, s12, 1
    s_add_u32 s13, s13, s10
    v_pk_mul_f32 v[184:185], v[184:185], v[32:33]
    v_pk_mul_f32 v[186:187], v[186:187], v[34:35]
    v_pk_mul_f32 v[188:189], v[188:189], v[36:37]
    v_pk_mul_f32 v[190:191], v[190:191], v[38:39]
    s_lshl_b32 s13, s13, 12
    s_and_b32 s12, s12, 1
    v_cvt_pk_bf16_f32 v44, v184, v185
    v_cvt_pk_bf16_f32 v45, v186, v187
    v_cvt_pk_bf16_f32 v46, v188, v189
    v_cvt_pk_bf16_f32 v47, v190, v191
    s_lshl_b32 s12, s12, 9
    s_add_u32 s13, s13, s12
    buffer_store_dwordx4 v[44:47], v3, s[64:67], s13 offen sc1
K1FS_20:
    s_waitcnt lgkmcnt(0)
    s_add_u32 s12, s11, 4
    s_cmp_ge_u32 s12, 108
    s_cbranch_scc1 K1FS_21
    v_pk_fma_f32 v[192:193], v[20:21], v[112:113], v[192:193] op_sel_hi:[0,1,1] neg_lo:[1,0,0] neg_hi:[1,0,0]
    v_pk_fma_f32 v[194:195], v[20:21], v[114:115], v[194:195] op_sel_hi:[0,1,1] neg_lo:[1,0,0] neg_hi:[1,0,0]
    v_pk_fma_f32 v[196:197], v[20:21], v[116:117], v[196:197] op_sel_hi:[0,1,1] neg_lo:[1,0,0] neg_hi:[1,0,0]
    v_pk_fma_f32 v[198:199], v[20:21], v[118:119], v[198:199] op_sel_hi:[0,1,1] neg_lo:[1,0,0] neg_hi:[1,0,0]
    v_pk_fma_f32 v[200:201], v[20:21], v[120:121], v[200:201] op_sel_hi:[0,1,1] neg_lo:[1,0,0] neg_hi:[1,0,0]
    v_pk_fma_f32 v[202:203], v[20:21], v[122:123], v[202:203] op_sel_hi:[0,1,1] neg_lo:[1,0,0] neg_hi:[1,0,0]
    v_pk_fma_f32 v[204:205], v[20:21], v[124:125], v[204:205] op_sel_hi:[0,1,1] neg_lo:[1,0,0] neg_hi:[1,0,0]
    v_pk_fma_f32 v[206:207], v[20:21], v[126:127], v[206:207] op_sel_hi:[0,1,1] neg_lo:[1,0,0] neg_hi:[1,0,0]
    v_pk_mul_f32 v[192:193], v[192:193], v[22:23] op_sel_hi:[1,0]
    v_pk_mul_f32 v[194:195], v[194:195], v[22:23] op_sel_hi:[1,0]
    v_pk_mul_f32 v[196:197], v[196:197], v[22:23] op_sel_hi:[1,0]
    v_pk_mul_f32 v[198:199], v[198:199], v[22:23] op_sel_hi:[1,0]
    v_pk_mul_f32 v[32:33], v[192:193], v[192:193]
    v_pk_mul_f32 v[34:35], v[194:195], v[194:195]
    v_pk_mul_f32 v[36:37], v[196:197], v[196:197]
    v_pk_mul_f32 v[38:39], v[198:199], v[198:199]
    v_pk_fma_f32 v[32:33], v[32:33], s[52:53], v[24:25] op_sel_hi:[1,1,0]
    v_pk_fma_f32 v[34:35], v[34:35], s[52:53], v[24:25] op_sel_hi:[1,1,0]
    v_pk_fma_f32 v[36:37], v[36:37], s[52:53], v[24:25] op_sel_hi:[1,1,0]
    v_pk_fma_f32 v[38:39], v[38:39], s[52:53], v[24:25] op_sel_hi:[1,1,0]
    v_pk_mul_f32 v[32:33], v[32:33], v[192:193]
    v_pk_mul_f32 v[34:35], v[34:35], v[194:195]
    v_pk_mul_f32 v[36:37], v[36:37], v[196:197]
    v_pk_mul_f32 v[38:39], v[38:39], v[198:199]
    v_exp_f32 v32, v32
    v_exp_f32 v33, v33
    v_exp_f32 v34, v34
    v_exp_f32 v35, v35
    v_exp_f32 v36, v36
    v_exp_f32 v37, v37
    v_exp_f32 v38, v38
    v_exp_f32 v39, v39
    v_pk_mul_f32 v[200:201], v[192:193], v[200:201]
    v_pk_mul_f32 v[202:203], v[194:195], v[202:203]
    v_pk_mul_f32 v[204:205], v[196:197], v[204:205]
    v_pk_mul_f32 v[206:207], v[198:199], v[206:207]
    v_pk_fma_f32 v[32:33], v[32:33], v[26:27], v[26:27] op_sel_hi:[1,0,0]
    v_pk_fma_f32 v[34:35], v[34:35], v[26:27], v[26:27] op_sel_hi:[1,0,0]
    v_pk_fma_f32 v[36:37], v[36:37], v[26:27], v[26:27] op_sel_hi:[1,0,0]
    v_pk_fma_f32 v[38:39], v[38:39], v[26:27], v[26:27] op_sel_hi:[1,0,0]
    v_rcp_f32 v32, v32
    v_rcp_f32 v33, v33
    v_rcp_f32 v34, v34
    v_rcp_f32 v35, v35
    v_rcp_f32 v36, v36
    v_rcp_f32 v37, v37
    v_rcp_f32 v38, v38
    v_rcp_f32 v39, v39
    s_lshr_b32 s13, s12, 1
    s_add_u32 s13, s13, s10
    v_pk_mul_f32 v[200:201], v[200:201], v[32:33]
    v_pk_mul_f32 v[202:203], v[202:203], v[34:35]
    v_pk_mul_f32 v[204:205], v[204:205], v[36:37]
    v_pk_mul_f32 v[206:207], v[206:207], v[38:39]
    s_lshl_b32 s13, s13, 12
    s_and_b32 s12, s12, 1
    v_cvt_pk_bf16_f32 v40, v200, v201
    v_cvt_pk_bf16_f32 v41, v202, v203
    v_cvt_pk_bf16_f32 v42, v204, v205
    v_cvt_pk_bf16_f32 v43, v206, v207
    s_lshl_b32 s12, s12, 9
    s_add_u32 s13, s13, s12
    buffer_store_dwordx4 v[40:43], v3, s[64:67], s13 offen sc1
K1FS_21:
    s_lshl_b32 s10, s6, 7
    s_lshl_b32 s11, s7, 2
    s_add_u32 s10, s10, s11
    s_add_u32 s10, s10, 32509952
    s_mov_b32 s71, s10
    s_branch PHASE2
K1_SSM:
    s_sub_u32 s7, s7, 11
    s_mov_b32 s52, s22
    s_mov_b32 s53, s23
    s_mov_b32 s54, 819200
    s_mov_b32 s55, 0x20000
    s_mov_b32 s56, s24
    s_mov_b32 s57, s25
    s_mov_b32 s58, 819200
    s_mov_b32 s59, 0x20000
    s_lshl_b32 s10, s7, 7
    s_lshl_b32 s11, s3, 4
    s_add_u32 s10, s10, s11
    v_lshrrev_b32 v3, 3, v2
    v_add_u32 v4, s10, v3
    v_mul_u32_u24 v10, 1280, v4
    v_add_u32 v11, 10240, v10
    v_lshl_add_u32 v10, v26, 4, v10
    v_lshl_add_u32 v11, v27, 4, v11
    s_mov_b32 s73, s74
    s_mov_b32 s75, 0
    s_mov_b32 s79, 0
    s_mov_b32 s80, s18
    s_mov_b32 s81, s19
    s_mov_b32 s82, 1280
    s_mov_b32 s83, 0x20000
    s_mov_b32 s84, s20
    s_mov_b32 s85, s21
    s_mov_b32 s86, 1280
    s_mov_b32 s87, 0x20000
    s_mov_b32 s88, s30
    s_mov_b32 s89, s31
    s_mov_b32 s90, 1280
    s_mov_b32 s91, 0x20000
    s_lshl_b32 s10, s7, 7
    s_lshl_b32 s11, s5, 6
    s_add_u32 s68, s10, s11
    v_and_b32 v3, 31, v2
    v_add_u32 v3, s68, v3
    v_lshlrev_b32 v7, 1, v3
    buffer_load_ushort v232, v7, s[80:83], 0 offen offset:0
    buffer_load_ushort v233, v7, s[84:87], 0 offen offset:0
    buffer_load_ushort v234, v7, s[88:91], 0 offen offset:0
    buffer_load_ushort v235, v7, s[80:83], 0 offen offset:64
    buffer_load_ushort v236, v7, s[84:87], 0 offen offset:64
    buffer_load_ushort v237, v7, s[88:91], 0 offen offset:64
    s_add_u32 s10, s75, s69
    s_add_u32 m0, s10, 0
    s_nop 0
    buffer_load_dwordx4 v8, s[48:51], s74 offen lds
    s_add_u32 s10, s75, s69
    s_add_u32 m0, s10, 1024
    s_nop 0
    buffer_load_dwordx4 v9, s[48:51], s74 offen lds
    s_add_u32 s10, s75, s69
    s_add_u32 m0, s10, 16384
    s_nop 0
    buffer_load_dwordx4 v10, s[52:55], s74 offen lds
    s_add_u32 s74, s74, 128
    s_cmp_ge_u32 s74, 1280
    s_cselect_b32 s74, 0, s74
    s_add_u32 s75, s75, 49152
    s_cmp_ge_u32 s75, 147456
    s_cselect_b32 s75, 0, s75
    s_add_u32 s10, s79, s69
    s_add_u32 m0, s10, 17408
    s_nop 0
    buffer_load_dwordx4 v11, s[52:55], s73 offen lds
    s_add_u32 s10, s79, s69
    s_add_u32 m0, s10, 32768
    s_nop 0
    buffer_load_dwordx4 v10, s[56:59], s73 offen lds
    s_add_u32 s10, s79, s69
    s_add_u32 m0, s10, 33792
    s_nop 0
    buffer_load_dwordx4 v11, s[56:59], s73 offen lds
    s_add_u32 s73, s73, 128
    s_cmp_ge_u32 s73, 1280
    s_cselect_b32 s73, 0, s73
    s_add_u32 s79, s79, 49152
    s_cmp_ge_u32 s79, 147456
    s_cselect_b32 s79, 0, s79
    s_barrier
    s_add_u32 s10, s75, s69
    s_add_u32 m0, s10, 0
    s_nop 0
    buffer_load_dwordx4 v8, s[48:51], s74 offen lds
    s_add_u32 s10, s75, s69
    s_add_u32 m0, s10, 1024
    s_nop 0
    buffer_load_dwordx4 v9, s[48:51], s74 offen lds
    s_add_u32 s10, s75, s69
    s_add_u32 m0, s10, 16384
    s_nop 0
    buffer_load_dwordx4 v10, s[52:55], s74 offen lds
    s_add_u32 s74, s74, 128
    s_cmp_ge_u32 s74, 1280
    s_cselect_b32 s74, 0, s74
    s_add_u32 s75, s75, 49152
    s_cmp_ge_u32 s75, 147456
    s_cselect_b32 s75, 0, s75
    v_bfe_u32 v3, v2, 2, 1
    v_lshlrev_b32 v3, 4, v3
    v_and_b32 v4, 3, v2
    v_add_u32 v3, v3, v4
    v_bfe_u32 v4, v2, 3, 2
    v_lshl_add_u32 v3, v4, 2, v3
    v_bfe_u32 v5, v3, 1, 3
    s_lshl_b32 s10, s4, 5
    v_add_u32 v3, s10, v3
    v_lshlrev_b32 v13, 7, v3
    v_lshrrev_b32 v4, 5, v2
    v_xor_b32 v5, v4, v5
    v_lshl_add_u32 v13, v5, 4, v13
    v_and_b32 v3, 31, v2
    s_lshl_b32 s10, s5, 6
    v_add_u32 v3, s10, v3
    v_lshlrev_b32 v14, 7, v3
    v_bfe_u32 v5, v2, 1, 3
    v_xor_b32 v5, v4, v5
    v_lshl_add_u32 v14, v5, 4, v14
    v_add_u32 v14, 16384, v14
    v_mov_b32 v128, 0
    v_mov_b32 v129, 0
    v_mov_b32 v130, 0
    v_mov_b32 v131, 0
    v_mov_b32 v132, 0
    v_mov_b32 v133, 0
    v_mov_b32 v134, 0
    v_mov_b32 v135, 0
    v_mov_b32 v136, 0
    v_mov_b32 v137, 0
    v_mov_b32 v138, 0
    v_mov_b32 v139, 0
    v_mov_b32 v140, 0
    v_mov_b32 v141, 0
    v_mov_b32 v142, 0
    v_mov_b32 v143, 0
    v_mov_b32 v144, 0
    v_mov_b32 v145, 0
    v_mov_b32 v146, 0
    v_mov_b32 v147, 0
    v_mov_b32 v148, 0
    v_mov_b32 v149, 0
    v_mov_b32 v150, 0
    v_mov_b32 v151, 0
    v_mov_b32 v152, 0
    v_mov_b32 v153, 0
    v_mov_b32 v154, 0
    v_mov_b32 v155, 0
    v_mov_b32 v156, 0
    v_mov_b32 v157, 0
    v_mov_b32 v158, 0
    v_mov_b32 v159, 0
    v_mov_b32 v160, 0
    v_mov_b32 v161, 0
    v_mov_b32 v162, 0
    v_mov_b32 v163, 0
    v_mov_b32 v164, 0
    v_mov_b32 v165, 0
    v_mov_b32 v166, 0
    v_mov_b32 v167, 0
    v_mov_b32 v168, 0
    v_mov_b32 v169, 0
    v_mov_b32 v170, 0
    v_mov_b32 v171, 0
    v_mov_b32 v172, 0
    v_mov_b32 v173, 0
    v_mov_b32 v174, 0
    v_mov_b32 v175, 0
    v_mov_b32 v176, 0
    v_mov_b32 v177, 0
    v_mov_b32 v178, 0
    v_mov_b32 v179, 0
    v_mov_b32 v180, 0
    v_mov_b32 v181, 0
    v_mov_b32 v182, 0
    v_mov_b32 v183, 0
    v_mov_b32 v184, 0
    v_mov_b32 v185, 0
    v_mov_b32 v186, 0
    v_mov_b32 v187, 0
    v_mov_b32 v188, 0
    v_mov_b32 v189, 0
    v_mov_b32 v190, 0
    v_mov_b32 v191, 0
    s_cmp_eq_u32 s4, s5
    s_cselect_b32 s1, 1, 0
    s_cmp_lt_u32 s6, 10
    s_cselect_b32 s1, s1, 0
    s_cmp_lt_u32 s3, 6
    s_cbranch_scc1 K1_SJ_S
    s_waitcnt vmcnt(15)
    v_mov_b32 v19, 0
    v_mov_b32 v20, 0
    v_mov_b32 v21, 0
    v_mov_b32 v22, 0
    v_dot2c_f32_bf16 v19, v208, v18
    v_dot2c_f32_bf16 v21, v208, v208
    v_dot2c_f32_bf16 v20, v209, v18
    v_dot2c_f32_bf16 v22, v209, v209
    v_dot2c_f32_bf16 v19, v210, v18
    v_dot2c_f32_bf16 v21, v210, v210
    v_dot2c_f32_bf16 v20, v211, v18
    v_dot2c_f32_bf16 v22, v211, v211
    v_dot2c_f32_bf16 v19, v212, v18
    v_dot2c_f32_bf16 v21, v212, v212
    v_dot2c_f32_bf16 v20, v213, v18
    v_dot2c_f32_bf16 v22, v213, v213
    v_dot2c_f32_bf16 v19, v214, v18
    v_dot2c_f32_bf16 v21, v214, v214
    v_dot2c_f32_bf16 v20, v215, v18
    v_dot2c_f32_bf16 v22, v215, v215
    v_dot2c_f32_bf16 v19, v216, v18
    v_dot2c_f32_bf16 v21, v216, v216
    v_dot2c_f32_bf16 v20, v217, v18
    v_dot2c_f32_bf16 v22, v217, v217
    v_dot2c_f32_bf16 v19, v218, v18
    v_dot2c_f32_bf16 v21, v218, v218
    v_dot2c_f32_bf16 v20, v219, v18
    v_dot2c_f32_bf16 v22, v219, v219
    v_dot2c_f32_bf16 v19, v220, v18
    v_dot2c_f32_bf16 v21, v220, v220
    v_dot2c_f32_bf16 v20, v221, v18
    v_dot2c_f32_bf16 v22, v221, v221
    v_dot2c_f32_bf16 v19, v222, v18
    v_dot2c_f32_bf16 v21, v222, v222
    v_dot2c_f32_bf16 v20, v223, v18
    v_dot2c_f32_bf16 v22, v223, v223
    v_dot2c_f32_bf16 v19, v224, v18
    v_dot2c_f32_bf16 v21, v224, v224
    v_dot2c_f32_bf16 v20, v225, v18
    v_dot2c_f32_bf16 v22, v225, v225
    v_dot2c_f32_bf16 v19, v226, v18
    v_dot2c_f32_bf16 v21, v226, v226
    v_dot2c_f32_bf16 v20, v227, v18
    v_dot2c_f32_bf16 v22, v227, v227
    s_nop 2
    v_add_f32 v19, v19, v20
    v_add_f32 v20, v21, v22
    s_nop 1
    v_add_f32_dpp v19, v19, v19 row_ror:8 row_mask:0xf bank_mask:0xf
    v_add_f32_dpp v20, v20, v20 row_ror:8 row_mask:0xf bank_mask:0xf
    s_nop 1
    v_add_f32_dpp v19, v19, v19 row_ror:4 row_mask:0xf bank_mask:0xf
    v_add_f32_dpp v20, v20, v20 row_ror:4 row_mask:0xf bank_mask:0xf
    s_nop 1
    v_add_f32_dpp v19, v19, v19 row_ror:2 row_mask:0xf bank_mask:0xf
    v_add_f32_dpp v20, v20, v20 row_ror:2 row_mask:0xf bank_mask:0xf
    s_nop 1
    v_add_f32_dpp v19, v19, v19 row_ror:1 row_mask:0xf bank_mask:0xf
    v_add_f32_dpp v20, v20, v20 row_ror:1 row_mask:0xf bank_mask:0xf
    v_mul_f32 v19, 0x3acccccd, v19
    v_mul_f32 v20, 0x3acccccd, v20
    v_fma_f32 v20, -v19, v19, v20
    v_max_f32 v20, 0, v20
    v_cvt_pk_bf16_f32 v21, v19, v20
    v_lshlrev_b32 v238, 16, v21
    v_and_b32 v21, 0xffff0000, v21
    v_add_f32 v21, 0x3727c5ac, v21
    v_cvt_pk_bf16_f32 v21, v21, v21
    v_and_b32 v21, 0xffff0000, v21
    v_sqrt_f32 v21, v21
    s_nop 0
    v_cvt_pk_bf16_f32 v21, v21, v21
    v_and_b32 v21, 0xffff0000, v21
    v_rcp_f32 v239, v21
K1_SJ_S:
    v_mov_b32 v22, 0
    v_mov_b32 v23, 0
    v_mov_b32 v24, 0
    v_mov_b32 v25, 0
    s_mul_i32 s11, s6, 5
    s_add_u32 s11, s11, s7
    s_add_u32 s11, s11, 352
    s_mul_hi_u32 s13, s11, 79536432
    s_mul_i32 s12, s13, 54
    s_sub_u32 s12, s11, s12
    s_mul_i32 s90, s12, 40960
    s_mul_i32 s15, s13, 160
    s_add_u32 s90, s90, s15
    s_mul_i32 s101, s13, 94
    s_add_u32 s101, s101, s12
    s_add_u32 s101, s101, 40
    s_mul_i32 s101, s101, 5120
    v_add_u32 v3, 0, v2
    s_mov_b32 s15, 429496730
    v_mul_hi_u32 v4, v3, s15
    v_mul_u32_u24 v5, 10, v4
    v_sub_u32 v5, v3, v5
    v_mul_u32_u24 v4, 1280, v4
    v_lshl_add_u32 v193, v5, 4, v4
    v_add_u32 v3, 64, v2
    s_mov_b32 s15, 429496730
    v_mul_hi_u32 v4, v3, s15
    v_mul_u32_u24 v5, 10, v4
    v_sub_u32 v5, v3, v5
    v_mul_u32_u24 v4, 1280, v4
    v_lshl_add_u32 v194, v5, 4, v4
    v_add_u32 v3, 128, v2
    s_mov_b32 s15, 429496730
    v_mul_hi_u32 v4, v3, s15
    v_mul_u32_u24 v5, 10, v4
    v_sub_u32 v5, v3, v5
    v_mul_u32_u24 v4, 1280, v4
    v_lshl_add_u32 v195, v5, 4, v4
    v_add_u32 v3, 192, v2
    s_mov_b32 s15, 429496730
    v_mul_hi_u32 v4, v3, s15
    v_mul_u32_u24 v5, 10, v4
    v_sub_u32 v5, v3, v5
    v_mul_u32_u24 v4, 1280, v4
    v_lshl_add_u32 v196, v5, 4, v4
    v_add_u32 v3, 256, v2
    s_mov_b32 s15, 429496730
    v_mul_hi_u32 v4, v3, s15
    v_mul_u32_u24 v5, 10, v4
    v_sub_u32 v5, v3, v5
    v_mul_u32_u24 v4, 1280, v4
    v_lshl_add_u32 v197, v5, 4, v4
    s_waitcnt vmcnt(9)
    v_lshlrev_b32 v232, 16, v232
    v_lshlrev_b32 v233, 16, v233
    v_lshlrev_b32 v234, 16, v234
    v_mul_f32 v240, 0x3fb8aa3b, v234
    v_exp_f32 v240, v240
    s_nop 0
    v_cvt_pk_bf16_f32 v240, v240, v240
    v_lshlrev_b32 v240, 16, v240
    v_mul_f32 v241, v240, v232
    v_mul_f32 v242, v240, v233
    v_mul_f32 v241, 0x3fb8aa3b, v241
    v_exp_f32 v241, v241
    v_mul_f32 v242, 0x3e22f983, v242
    v_fract_f32 v242, v242
    v_cos_f32 v243, v242
    v_sin_f32 v244, v242
    s_nop 0
    v_mul_f32 v208, v241, v243
    v_mul_f32 v209, v241, v244
    v_add_f32 v243, -1.0, v208
    v_mul_f32 v244, v232, v232
    v_fmac_f32 v244, v233, v233
    v_rcp_f32 v244, v244
    v_mul_f32 v245, v243, v232
    v_fmac_f32 v245, v209, v233
    v_mul_f32 v246, v209, v232
    v_fma_f32 v246, -v243, v233, v246
    v_add_f32 v244, v244, v244
    v_mul_f32 v210, v245, v244
    v_mul_f32 v211, v246, v244
    v_mul_f32 v240, v209, v209
    v_mul_f32 v241, v208, v209
    v_fma_f32 v212, v208, v208, -v240
    v_add_f32 v213, v241, v241
    v_mul_f32 v240, v213, v213
    v_mul_f32 v241, v212, v213
    v_fma_f32 v212, v212, v212, -v240
    v_add_f32 v213, v241, v241
    v_mul_f32 v240, v213, v213
    v_mul_f32 v241, v212, v213
    v_fma_f32 v212, v212, v212, -v240
    v_add_f32 v213, v241, v241
    v_mul_f32 v240, v213, v213
    v_mul_f32 v241, v212, v213
    v_fma_f32 v212, v212, v212, -v240
    v_add_f32 v213, v241, v241
    v_mul_f32 v240, v213, v213
    v_mul_f32 v241, v212, v213
    v_fma_f32 v214, v212, v212, -v240
    v_add_f32 v215, v241, v241
    v_mul_f32 v240, v215, v215
    v_mul_f32 v241, v214, v215
    v_fma_f32 v214, v214, v214, -v240
    v_add_f32 v215, v241, v241
    v_mul_f32 v240, v215, v215
    v_mul_f32 v241, v214, v215
    v_fma_f32 v214, v214, v214, -v240
    v_add_f32 v215, v241, v241
    v_lshlrev_b32 v235, 16, v235
    v_lshlrev_b32 v236, 16, v236
    v_lshlrev_b32 v237, 16, v237
    v_mul_f32 v240, 0x3fb8aa3b, v237
    v_exp_f32 v240, v240
    s_nop 0
    v_cvt_pk_bf16_f32 v240, v240, v240
    v_lshlrev_b32 v240, 16, v240
    v_mul_f32 v241, v240, v235
    v_mul_f32 v242, v240, v236
    v_mul_f32 v241, 0x3fb8aa3b, v241
    v_exp_f32 v241, v241
    v_mul_f32 v242, 0x3e22f983, v242
    v_fract_f32 v242, v242
    v_cos_f32 v243, v242
    v_sin_f32 v244, v242
    s_nop 0
    v_mul_f32 v216, v241, v243
    v_mul_f32 v217, v241, v244
    v_add_f32 v243, -1.0, v216
    v_mul_f32 v244, v235, v235
    v_fmac_f32 v244, v236, v236
    v_rcp_f32 v244, v244
    v_mul_f32 v245, v243, v235
    v_fmac_f32 v245, v217, v236
    v_mul_f32 v246, v217, v235
    v_fma_f32 v246, -v243, v236, v246
    v_add_f32 v244, v244, v244
    v_mul_f32 v218, v245, v244
    v_mul_f32 v219, v246, v244
    v_mul_f32 v240, v217, v217
    v_mul_f32 v241, v216, v217
    v_fma_f32 v220, v216, v216, -v240
    v_add_f32 v221, v241, v241
    v_mul_f32 v240, v221, v221
    v_mul_f32 v241, v220, v221
    v_fma_f32 v220, v220, v220, -v240
    v_add_f32 v221, v241, v241
    v_mul_f32 v240, v221, v221
    v_mul_f32 v241, v220, v221
    v_fma_f32 v220, v220, v220, -v240
    v_add_f32 v221, v241, v241
    v_mul_f32 v240, v221, v221
    v_mul_f32 v241, v220, v221
    v_fma_f32 v220, v220, v220, -v240
    v_add_f32 v221, v241, v241
    v_mul_f32 v240, v221, v221
    v_mul_f32 v241, v220, v221
    v_fma_f32 v222, v220, v220, -v240
    v_add_f32 v223, v241, v241
    v_mul_f32 v240, v223, v223
    v_mul_f32 v241, v222, v223
    v_fma_f32 v222, v222, v222, -v240
    v_add_f32 v223, v241, v241
    v_mul_f32 v240, v223, v223
    v_mul_f32 v241, v222, v223
    v_fma_f32 v222, v222, v222, -v240
    v_add_f32 v223, v241, v241
    s_waitcnt vmcnt(3)
    s_barrier
    s_mov_b32 s76, 0
    v_add_u32 v15, s76, v13
    v_add_u32 v17, s76, v14
    v_xor_b32 v16, 32, v15
    v_xor_b32 v21, 32, v17
    ds_read_b128 v[32:35], v15
    ds_read_b128 v[36:39], v17 offset:0
    ds_read_b128 v[40:43], v17 offset:16384
    ds_read_b128 v[44:47], v17 offset:4096
    ds_read_b128 v[48:51], v17 offset:20480
    ds_read_b128 v[52:55], v16
    ds_read_b128 v[56:59], v21 offset:0
    ds_read_b128 v[60:63], v21 offset:16384
    ds_read_b128 v[64:67], v21 offset:4096
    ds_read_b128 v[68:71], v21 offset:20480
    v_mov_b32 v3, 0
    global_load_dword v247, v3, s[44:45] sc1
    s_add_u32 s10, s79, s69
    s_add_u32 m0, s10, 17408
    s_nop 0
    buffer_load_dwordx4 v11, s[52:55], s73 offen lds
    s_add_u32 s10, s79, s69
    s_add_u32 m0, s10, 32768
    s_nop 0
    buffer_load_dwordx4 v10, s[56:59], s73 offen lds
    s_add_u32 s10, s79, s69
    s_add_u32 m0, s10, 33792
    s_nop 0
    buffer_load_dwordx4 v11, s[56:59], s73 offen lds
    s_add_u32 s73, s73, 128
    s_cmp_ge_u32 s73, 1280
    s_cselect_b32 s73, 0, s73
    s_add_u32 s79, s79, 49152
    s_cmp_ge_u32 s79, 147456
    s_cselect_b32 s79, 0, s79
    s_add_u32 s10, s75, s69
    s_add_u32 m0, s10, 0
    s_nop 0
    buffer_load_dwordx4 v8, s[48:51], s74 offen lds
    s_add_u32 s10, s75, s69
    s_add_u32 m0, s10, 1024
    s_nop 0
    buffer_load_dwordx4 v9, s[48:51], s74 offen lds
    s_add_u32 s10, s75, s69
    s_add_u32 m0, s10, 16384
    s_nop 0
    buffer_load_dwordx4 v10, s[52:55], s74 offen lds
    s_add_u32 s74, s74, 128
    s_cmp_ge_u32 s74, 1280
    s_cselect_b32 s74, 0, s74
    s_add_u32 s75, s75, 49152
    s_cmp_ge_u32 s75, 147456
    s_cselect_b32 s75, 0, s75
    s_add_u32 s80, s46, 31457280
    s_addc_u32 s81, s47, 0
    s_mov_b32 s82, 384000
    s_mov_b32 s83, 0x20000
    s_add_u32 s84, s46, 30408704
    s_addc_u32 s85, s47, 0
    s_mov_b32 s86, 32768
    s_mov_b32 s87, 0x20000
    v_lshlrev_b32 v29, 3, v0
    v_cmp_gt_u32 vcc, 256, v0
    v_mov_b32 v3, 0x7ffffff0
    s_mul_i32 s88, s7, 20480
    s_add_u32 s88, s88, 281600
    v_cndmask_b32 v29, v3, v29, vcc
    v_subrev_u32 v4, 256, v0
    v_cmp_gt_u32 vcc, 128, v4
    s_lshl_b32 s10, s6, 7
    v_add_u32 v4, s10, v4
    v_lshlrev_b32 v30, 4, v4
    v_cndmask_b32 v30, v3, v30, vcc
    s_waitcnt lgkmcnt(0)
    v_mfma_f32_32x32x16_bf16 v[128:143], v[32:35], v[36:39], v[128:143]
    v_add_u32 v15, s76, v13
    v_add_u32 v17, s76, v14
    v_xor_b32 v15, 64, v15
    v_xor_b32 v17, 64, v17
    v_xor_b32 v16, 32, v15
    v_xor_b32 v21, 32, v17
    s_add_u32 s76, s76, 49152
    s_cmp_ge_u32 s76, 147456
    s_cselect_b32 s76, 0, s76
    v_mfma_f32_32x32x16_bf16 v[144:159], v[32:35], v[40:43], v[144:159]
    ds_read_b128 v[80:83], v15
    ds_read_b128 v[84:87], v17 offset:0
    ds_read_b128 v[88:91], v17 offset:16384
    s_add_u32 s10, s79, s69
    s_add_u32 m0, s10, 17408
    s_nop 0
    buffer_load_dwordx4 v11, s[52:55], s73 offen lds
    v_mfma_f32_32x32x16_bf16 v[160:175], v[32:35], v[44:47], v[160:175]
    ds_read_b128 v[92:95], v17 offset:4096
    ds_read_b128 v[96:99], v17 offset:20480
    ds_read_b128 v[100:103], v16
    v_mfma_f32_32x32x16_bf16 v[176:191], v[32:35], v[48:51], v[176:191]
    ds_read_b128 v[104:107], v21 offset:0
    ds_read_b128 v[108:111], v21 offset:16384
    ds_read_b128 v[112:115], v21 offset:4096
    s_add_u32 s10, s79, s69
    s_add_u32 m0, s10, 32768
    s_nop 0
    buffer_load_dwordx4 v10, s[56:59], s73 offen lds
    v_mfma_f32_32x32x16_bf16 v[128:143], v[52:55], v[56:59], v[128:143]
    ds_read_b128 v[116:119], v21 offset:20480
    v_mfma_f32_32x32x16_bf16 v[144:159], v[52:55], v[60:63], v[144:159]
    s_add_u32 s10, s79, s69
    s_add_u32 m0, s10, 33792
    s_nop 0
    buffer_load_dwordx4 v11, s[56:59], s73 offen lds
    v_mfma_f32_32x32x16_bf16 v[160:175], v[52:55], v[64:67], v[160:175]
    s_add_u32 s73, s73, 128
    s_cmp_ge_u32 s73, 1280
    s_cselect_b32 s73, 0, s73
    s_add_u32 s79, s79, 49152
    s_cmp_ge_u32 s79, 147456
    s_cselect_b32 s79, 0, s79
    s_cmp_eq_u32 s1, 0
    s_cbranch_scc1 K1C_22
    v_dot2c_f32_bf16 v22, v36, v18
    v_dot2c_f32_bf16 v23, v40, v18
    v_dot2c_f32_bf16 v24, v44, v18
    v_dot2c_f32_bf16 v25, v48, v18
    v_dot2c_f32_bf16 v22, v37, v18
    v_dot2c_f32_bf16 v23, v41, v18
    v_dot2c_f32_bf16 v24, v45, v18
    v_dot2c_f32_bf16 v25, v49, v18
    v_dot2c_f32_bf16 v22, v38, v18
    v_dot2c_f32_bf16 v23, v42, v18
    v_dot2c_f32_bf16 v24, v46, v18
    v_dot2c_f32_bf16 v25, v50, v18
    v_dot2c_f32_bf16 v22, v39, v18
    v_dot2c_f32_bf16 v23, v43, v18
    v_dot2c_f32_bf16 v24, v47, v18
    v_dot2c_f32_bf16 v25, v51, v18
    v_dot2c_f32_bf16 v22, v56, v18
    v_dot2c_f32_bf16 v23, v60, v18
    v_dot2c_f32_bf16 v24, v64, v18
    v_dot2c_f32_bf16 v25, v68, v18
    v_dot2c_f32_bf16 v22, v57, v18
    v_dot2c_f32_bf16 v23, v61, v18
    v_dot2c_f32_bf16 v24, v65, v18
    v_dot2c_f32_bf16 v25, v69, v18
    v_dot2c_f32_bf16 v22, v58, v18
    v_dot2c_f32_bf16 v23, v62, v18
    v_dot2c_f32_bf16 v24, v66, v18
    v_dot2c_f32_bf16 v25, v70, v18
    v_dot2c_f32_bf16 v22, v59, v18
    v_dot2c_f32_bf16 v23, v63, v18
    v_dot2c_f32_bf16 v24, v67, v18
    v_dot2c_f32_bf16 v25, v71, v18
K1C_22:
    v_mfma_f32_32x32x16_bf16 v[176:191], v[52:55], v[68:71], v[176:191]
    s_waitcnt vmcnt(6) lgkmcnt(0)
    s_barrier
    v_mfma_f32_32x32x16_bf16 v[128:143], v[80:83], v[84:87], v[128:143]
    v_add_u32 v15, s76, v13
    v_add_u32 v17, s76, v14
    v_xor_b32 v16, 32, v15
    v_xor_b32 v21, 32, v17
    v_mfma_f32_32x32x16_bf16 v[144:159], v[80:83], v[88:91], v[144:159]
    ds_read_b128 v[32:35], v15
    ds_read_b128 v[36:39], v17 offset:0
    ds_read_b128 v[40:43], v17 offset:16384
    s_add_u32 s10, s75, s69
    s_add_u32 m0, s10, 0
    s_nop 0
    buffer_load_dwordx4 v8, s[48:51], s74 offen lds
    v_mfma_f32_32x32x16_bf16 v[160:175], v[80:83], v[92:95], v[160:175]
    ds_read_b128 v[44:47], v17 offset:4096
    ds_read_b128 v[48:51], v17 offset:20480
    ds_read_b128 v[52:55], v16
    v_mfma_f32_32x32x16_bf16 v[176:191], v[80:83], v[96:99], v[176:191]
    ds_read_b128 v[56:59], v21 offset:0
    ds_read_b128 v[60:63], v21 offset:16384
    ds_read_b128 v[64:67], v21 offset:4096
    s_add_u32 s10, s75, s69
    s_add_u32 m0, s10, 1024
    s_nop 0
    buffer_load_dwordx4 v9, s[48:51], s74 offen lds
    v_mfma_f32_32x32x16_bf16 v[128:143], v[100:103], v[104:107], v[128:143]
    ds_read_b128 v[68:71], v21 offset:20480
    v_mfma_f32_32x32x16_bf16 v[144:159], v[100:103], v[108:111], v[144:159]
    s_add_u32 s10, s75, s69
    s_add_u32 m0, s10, 16384
    s_nop 0
    buffer_load_dwordx4 v10, s[52:55], s74 offen lds
    v_mfma_f32_32x32x16_bf16 v[160:175], v[100:103], v[112:115], v[160:175]
    s_add_u32 s74, s74, 128
    s_cmp_ge_u32 s74, 1280
    s_cselect_b32 s74, 0, s74
    s_add_u32 s75, s75, 49152
    s_cmp_ge_u32 s75, 147456
    s_cselect_b32 s75, 0, s75
    s_cmp_eq_u32 s1, 0
    s_cbranch_scc1 K1C_23
    v_dot2c_f32_bf16 v22, v84, v18
    v_dot2c_f32_bf16 v23, v88, v18
    v_dot2c_f32_bf16 v24, v92, v18
    v_dot2c_f32_bf16 v25, v96, v18
    v_dot2c_f32_bf16 v22, v85, v18
    v_dot2c_f32_bf16 v23, v89, v18
    v_dot2c_f32_bf16 v24, v93, v18
    v_dot2c_f32_bf16 v25, v97, v18
    v_dot2c_f32_bf16 v22, v86, v18
    v_dot2c_f32_bf16 v23, v90, v18
    v_dot2c_f32_bf16 v24, v94, v18
    v_dot2c_f32_bf16 v25, v98, v18
    v_dot2c_f32_bf16 v22, v87, v18
    v_dot2c_f32_bf16 v23, v91, v18
    v_dot2c_f32_bf16 v24, v95, v18
    v_dot2c_f32_bf16 v25, v99, v18
    v_dot2c_f32_bf16 v22, v104, v18
    v_dot2c_f32_bf16 v23, v108, v18
    v_dot2c_f32_bf16 v24, v112, v18
    v_dot2c_f32_bf16 v25, v116, v18
    v_dot2c_f32_bf16 v22, v105, v18
    v_dot2c_f32_bf16 v23, v109, v18
    v_dot2c_f32_bf16 v24, v113, v18
    v_dot2c_f32_bf16 v25, v117, v18
    v_dot2c_f32_bf16 v22, v106, v18
    v_dot2c_f32_bf16 v23, v110, v18
    v_dot2c_f32_bf16 v24, v114, v18
    v_dot2c_f32_bf16 v25, v118, v18
    v_dot2c_f32_bf16 v22, v107, v18
    v_dot2c_f32_bf16 v23, v111, v18
    v_dot2c_f32_bf16 v24, v115, v18
    v_dot2c_f32_bf16 v25, v119, v18
    v_mov_b32 v224, v22
    v_mov_b32 v226, v23
    v_mov_b32 v228, v24
    v_mov_b32 v230, v25
    s_nop 1
    v_permlane32_swap_b32 v22, v224
    v_permlane32_swap_b32 v23, v226
    v_permlane32_swap_b32 v24, v228
    v_permlane32_swap_b32 v25, v230
    v_add_f32 v224, v22, v224
    v_add_f32 v226, v23, v226
    v_add_f32 v228, v24, v228
    v_add_f32 v230, v25, v230
    v_readfirstlane_b32 s10, v247
    s_cmp_lg_u32 s10, 0
    s_cbranch_scc1 K1_EN1_SC
    v_mov_b32 v3, 0
    s_mov_b32 s11, 30000
K1_EN0_SC:
    global_load_dword v247, v3, s[44:45] sc1
    s_waitcnt vmcnt(0)
    v_readfirstlane_b32 s10, v247
    s_sub_u32 s11, s11, 1
    s_cmp_eq_u32 s11, 0
    s_cbranch_scc1 K1_EN1_SC
    s_cmp_eq_u32 s10, 0
    s_cbranch_scc1 K1_EN0_SC
K1_EN1_SC:
    v_mov_b32 v225, v247
    v_mov_b32 v227, v247
    v_mov_b32 v229, v247
    v_mov_b32 v231, v247
    v_and_b32 v3, 31, v2
    s_lshl_b32 s10, s5, 7
    v_add_u32 v3, s10, v3
    v_lshlrev_b32 v3, 3, v3
    s_lshl_b32 s10, s0, 11
    s_add_u32 s10, s10, s88
    s_mov_b32 exec_hi, 0
    buffer_store_dwordx2 v[224:225], v3, s[80:83], s10 offen offset:0 sc1
    buffer_store_dwordx2 v[226:227], v3, s[80:83], s10 offen offset:256 sc1
    buffer_store_dwordx2 v[228:229], v3, s[80:83], s10 offen offset:512 sc1
    buffer_store_dwordx2 v[230:231], v3, s[80:83], s10 offen offset:768 sc1
    s_mov_b32 exec_hi, -1
K1C_23:
    s_mov_b32 s77, 1
    s_cmp_lt_u32 s3, 6
    s_cbranch_scc1 K1_SP_S
    s_cmp_eq_u32 s77, 1
    s_cbranch_scc0 K1_SP_S
    v_readfirstlane_b32 s10, v247
    s_cmp_lg_u32 s10, 0
    s_cbranch_scc1 K1_EN1_SP
    v_mov_b32 v3, 0
    s_mov_b32 s11, 30000
K1_EN0_SP:
    global_load_dword v247, v3, s[44:45] sc1
    s_waitcnt vmcnt(0)
    v_readfirstlane_b32 s10, v247
    s_sub_u32 s11, s11, 1
    s_cmp_eq_u32 s11, 0
    s_cbranch_scc1 K1_EN1_SP
    s_cmp_eq_u32 s10, 0
    s_cbranch_scc1 K1_EN0_SP
K1_EN1_SP:
    v_mov_b32 v240, v238
    v_mov_b32 v241, v239
    v_mov_b32 v242, v247
    v_not_b32 v243, v247
    v_lshlrev_b32 v3, 4, v28
    v_and_b32 v4, 15, v2
    v_cmp_eq_u32 vcc, 0, v4
    s_and_saveexec_b64 s[10:11], vcc
    buffer_store_dwordx4 v[240:243], v3, s[84:87], 0 offen sc1
    s_mov_b64 exec, s[10:11]
K1_SP_S:
    v_mfma_f32_32x32x16_bf16 v[176:191], v[100:103], v[116:119], v[176:191]
    s_mov_b32 s77, 6
K1S_LOOP:
    s_waitcnt lgkmcnt(0)
    v_mfma_f32_32x32x16_bf16 v[128:143], v[32:35], v[36:39], v[128:143]
    v_add_u32 v15, s76, v13
    v_add_u32 v17, s76, v14
    v_xor_b32 v15, 64, v15
    v_xor_b32 v17, 64, v17
    v_xor_b32 v16, 32, v15
    v_xor_b32 v21, 32, v17
    s_add_u32 s76, s76, 49152
    s_cmp_ge_u32 s76, 147456
    s_cselect_b32 s76, 0, s76
    v_mfma_f32_32x32x16_bf16 v[144:159], v[32:35], v[40:43], v[144:159]
    ds_read_b128 v[80:83], v15
    ds_read_b128 v[84:87], v17 offset:0
    ds_read_b128 v[88:91], v17 offset:16384
    s_add_u32 s10, s79, s69
    s_add_u32 m0, s10, 17408
    s_nop 0
    buffer_load_dwordx4 v11, s[52:55], s73 offen lds
    v_mfma_f32_32x32x16_bf16 v[160:175], v[32:35], v[44:47], v[160:175]
    ds_read_b128 v[92:95], v17 offset:4096
    ds_read_b128 v[96:99], v17 offset:20480
    ds_read_b128 v[100:103], v16
    v_mfma_f32_32x32x16_bf16 v[176:191], v[32:35], v[48:51], v[176:191]
    ds_read_b128 v[104:107], v21 offset:0
    ds_read_b128 v[108:111], v21 offset:16384
    ds_read_b128 v[112:115], v21 offset:4096
    s_add_u32 s10, s79, s69
    s_add_u32 m0, s10, 32768
    s_nop 0
    buffer_load_dwordx4 v10, s[56:59], s73 offen lds
    v_mfma_f32_32x32x16_bf16 v[128:143], v[52:55], v[56:59], v[128:143]
    ds_read_b128 v[116:119], v21 offset:20480
    v_mfma_f32_32x32x16_bf16 v[144:159], v[52:55], v[60:63], v[144:159]
    s_add_u32 s10, s79, s69
    s_add_u32 m0, s10, 33792
    s_nop 0
    buffer_load_dwordx4 v11, s[56:59], s73 offen lds
    v_mfma_f32_32x32x16_bf16 v[160:175], v[52:55], v[64:67], v[160:175]
    s_add_u32 s73, s73, 128
    s_cmp_ge_u32 s73, 1280
    s_cselect_b32 s73, 0, s73
    s_add_u32 s79, s79, 49152
    s_cmp_ge_u32 s79, 147456
    s_cselect_b32 s79, 0, s79
    v_mfma_f32_32x32x16_bf16 v[176:191], v[52:55], v[68:71], v[176:191]
    s_waitcnt vmcnt(6) lgkmcnt(0)
    s_barrier
    v_mfma_f32_32x32x16_bf16 v[128:143], v[80:83], v[84:87], v[128:143]
    v_add_u32 v15, s76, v13
    v_add_u32 v17, s76, v14
    v_xor_b32 v16, 32, v15
    v_xor_b32 v21, 32, v17
    v_mfma_f32_32x32x16_bf16 v[144:159], v[80:83], v[88:91], v[144:159]
    ds_read_b128 v[32:35], v15
    ds_read_b128 v[36:39], v17 offset:0
    ds_read_b128 v[40:43], v17 offset:16384
    s_add_u32 s10, s75, s69
    s_add_u32 m0, s10, 0
    s_nop 0
    buffer_load_dwordx4 v8, s[48:51], s74 offen lds
    v_mfma_f32_32x32x16_bf16 v[160:175], v[80:83], v[92:95], v[160:175]
    ds_read_b128 v[44:47], v17 offset:4096
    ds_read_b128 v[48:51], v17 offset:20480
    ds_read_b128 v[52:55], v16
    v_mfma_f32_32x32x16_bf16 v[176:191], v[80:83], v[96:99], v[176:191]
    ds_read_b128 v[56:59], v21 offset:0
    ds_read_b128 v[60:63], v21 offset:16384
    ds_read_b128 v[64:67], v21 offset:4096
    s_add_u32 s10, s75, s69
    s_add_u32 m0, s10, 1024
    s_nop 0
    buffer_load_dwordx4 v9, s[48:51], s74 offen lds
    v_mfma_f32_32x32x16_bf16 v[128:143], v[100:103], v[104:107], v[128:143]
    ds_read_b128 v[68:71], v21 offset:20480
    v_mfma_f32_32x32x16_bf16 v[144:159], v[100:103], v[108:111], v[144:159]
    s_add_u32 s10, s75, s69
    s_add_u32 m0, s10, 16384
    s_nop 0
    buffer_load_dwordx4 v10, s[52:55], s74 offen lds
    v_mfma_f32_32x32x16_bf16 v[160:175], v[100:103], v[112:115], v[160:175]
    s_add_u32 s74, s74, 128
    s_cmp_ge_u32 s74, 1280
    s_cselect_b32 s74, 0, s74
    s_add_u32 s75, s75, 49152
    s_cmp_ge_u32 s75, 147456
    s_cselect_b32 s75, 0, s75
    s_cmp_eq_u32 s77, 6
    s_cbranch_scc1 HK_S_I
HK_S_I_B:
    s_cmp_eq_u32 s77, 4
    s_cbranch_scc1 HK_S_F
HK_S_F_B:
    s_cmp_eq_u32 s77, 2
    s_cbranch_scc1 HK_S_A
HK_S_A_B:
    v_mfma_f32_32x32x16_bf16 v[176:191], v[100:103], v[116:119], v[176:191]
    s_sub_u32 s77, s77, 1
    s_cmp_lg_u32 s77, 0
    s_cbranch_scc1 K1S_LOOP
    s_waitcnt lgkmcnt(0)
    v_mfma_f32_32x32x16_bf16 v[128:143], v[32:35], v[36:39], v[128:143]
    v_add_u32 v15, s76, v13
    v_add_u32 v17, s76, v14
    v_xor_b32 v15, 64, v15
    v_xor_b32 v17, 64, v17
    v_xor_b32 v16, 32, v15
    v_xor_b32 v21, 32, v17
    s_add_u32 s76, s76, 49152
    s_cmp_ge_u32 s76, 147456
    s_cselect_b32 s76, 0, s76
    v_mfma_f32_32x32x16_bf16 v[144:159], v[32:35], v[40:43], v[144:159]
    ds_read_b128 v[80:83], v15
    ds_read_b128 v[84:87], v17 offset:0
    ds_read_b128 v[88:91], v17 offset:16384
    s_add_u32 s10, s79, s69
    s_add_u32 m0, s10, 17408
    s_nop 0
    buffer_load_dwordx4 v11, s[52:55], s73 offen lds
    v_mfma_f32_32x32x16_bf16 v[160:175], v[32:35], v[44:47], v[160:175]
    ds_read_b128 v[92:95], v17 offset:4096
    ds_read_b128 v[96:99], v17 offset:20480
    ds_read_b128 v[100:103], v16
    v_mfma_f32_32x32x16_bf16 v[176:191], v[32:35], v[48:51], v[176:191]
    ds_read_b128 v[104:107], v21 offset:0
    ds_read_b128 v[108:111], v21 offset:16384
    ds_read_b128 v[112:115], v21 offset:4096
    s_add_u32 s10, s79, s69
    s_add_u32 m0, s10, 32768
    s_nop 0
    buffer_load_dwordx4 v10, s[56:59], s73 offen lds
    v_mfma_f32_32x32x16_bf16 v[128:143], v[52:55], v[56:59], v[128:143]
    ds_read_b128 v[116:119], v21 offset:20480
    v_mfma_f32_32x32x16_bf16 v[144:159], v[52:55], v[60:63], v[144:159]
    s_add_u32 s10, s79, s69
    s_add_u32 m0, s10, 33792
    s_nop 0
    buffer_load_dwordx4 v11, s[56:59], s73 offen lds
    v_mfma_f32_32x32x16_bf16 v[160:175], v[52:55], v[64:67], v[160:175]
    s_add_u32 s73, s73, 128
    s_cmp_ge_u32 s73, 1280
    s_cselect_b32 s73, 0, s73
    s_add_u32 s79, s79, 49152
    s_cmp_ge_u32 s79, 147456
    s_cselect_b32 s79, 0, s79
    s_cmp_eq_u32 s3, 0
    s_cbranch_scc0 K1_AC_CBS
    v_readfirstlane_b32 s10, v31
    s_cmp_eq_u32 s10, 255
    s_cbranch_scc0 K1_AC_CBS
    v_readfirstlane_b32 s10, v247
    s_cmp_lg_u32 s10, 0
    s_cbranch_scc1 K1_EN1_ACCBS
    v_mov_b32 v3, 0
    s_mov_b32 s11, 30000
K1_EN0_ACCBS:
    global_load_dword v247, v3, s[44:45] sc1
    s_waitcnt vmcnt(0)
    v_readfirstlane_b32 s10, v247
    s_sub_u32 s11, s11, 1
    s_cmp_eq_u32 s11, 0
    s_cbranch_scc1 K1_EN1_ACCBS
    s_cmp_eq_u32 s10, 0
    s_cbranch_scc1 K1_EN0_ACCBS
K1_EN1_ACCBS:
    s_mov_b32 s11, 32505856
    v_lshlrev_b32 v27, 7, v2
    v_add_u32 v27, s11, v27
    s_mov_b32 exec_hi, 0
    global_store_dword v27, v247, s[46:47] sc1
    s_mov_b64 exec, -1
K1_AC_CBS:
    v_mfma_f32_32x32x16_bf16 v[176:191], v[52:55], v[68:71], v[176:191]
    s_waitcnt vmcnt(6) lgkmcnt(0)
    s_barrier
    v_mfma_f32_32x32x16_bf16 v[128:143], v[80:83], v[84:87], v[128:143]
    v_add_u32 v15, s76, v13
    v_add_u32 v17, s76, v14
    v_xor_b32 v16, 32, v15
    v_xor_b32 v21, 32, v17
    v_mfma_f32_32x32x16_bf16 v[144:159], v[80:83], v[88:91], v[144:159]
    ds_read_b128 v[32:35], v15
    ds_read_b128 v[36:39], v17 offset:0
    ds_read_b128 v[40:43], v17 offset:16384
    v_mfma_f32_32x32x16_bf16 v[160:175], v[80:83], v[92:95], v[160:175]
    ds_read_b128 v[44:47], v17 offset:4096
    ds_read_b128 v[48:51], v17 offset:20480
    ds_read_b128 v[52:55], v16
    v_mfma_f32_32x32x16_bf16 v[176:191], v[80:83], v[96:99], v[176:191]
    ds_read_b128 v[56:59], v21 offset:0
    ds_read_b128 v[60:63], v21 offset:16384
    ds_read_b128 v[64:67], v21 offset:4096
    v_mfma_f32_32x32x16_bf16 v[128:143], v[100:103], v[104:107], v[128:143]
    ds_read_b128 v[68:71], v21 offset:20480
    v_mfma_f32_32x32x16_bf16 v[144:159], v[100:103], v[108:111], v[144:159]
    v_mfma_f32_32x32x16_bf16 v[160:175], v[100:103], v[112:115], v[160:175]
    v_mfma_f32_32x32x16_bf16 v[176:191], v[100:103], v[116:119], v[176:191]
    s_waitcnt lgkmcnt(0)
    v_mfma_f32_32x32x16_bf16 v[128:143], v[32:35], v[36:39], v[128:143]
    v_add_u32 v15, s76, v13
    v_add_u32 v17, s76, v14
    v_xor_b32 v15, 64, v15
    v_xor_b32 v17, 64, v17
    v_xor_b32 v16, 32, v15
    v_xor_b32 v21, 32, v17
    s_add_u32 s76, s76, 49152
    s_cmp_ge_u32 s76, 147456
    s_cselect_b32 s76, 0, s76
    v_mfma_f32_32x32x16_bf16 v[144:159], v[32:35], v[40:43], v[144:159]
    ds_read_b128 v[80:83], v15
    ds_read_b128 v[84:87], v17 offset:0
    ds_read_b128 v[88:91], v17 offset:16384
    v_mfma_f32_32x32x16_bf16 v[160:175], v[32:35], v[44:47], v[160:175]
    ds_read_b128 v[92:95], v17 offset:4096
    ds_read_b128 v[96:99], v17 offset:20480
    ds_read_b128 v[100:103], v16
    v_mfma_f32_32x32x16_bf16 v[176:191], v[32:35], v[48:51], v[176:191]
    ds_read_b128 v[104:107], v21 offset:0
    ds_read_b128 v[108:111], v21 offset:16384
    ds_read_b128 v[112:115], v21 offset:4096
    v_mfma_f32_32x32x16_bf16 v[128:143], v[52:55], v[56:59], v[128:143]
    ds_read_b128 v[116:119], v21 offset:20480
    v_mfma_f32_32x32x16_bf16 v[144:159], v[52:55], v[60:63], v[144:159]
    v_mfma_f32_32x32x16_bf16 v[160:175], v[52:55], v[64:67], v[160:175]
    s_add_u32 s12, s88, 0
    buffer_load_dwordx2 v[224:225], v29, s[80:83], s12 offen sc1
    s_add_u32 s12, s88, 2048
    buffer_load_dwordx2 v[226:227], v29, s[80:83], s12 offen sc1
    s_add_u32 s12, s88, 4096
    buffer_load_dwordx2 v[228:229], v29, s[80:83], s12 offen sc1
    s_add_u32 s12, s88, 6144
    buffer_load_dwordx2 v[230:231], v29, s[80:83], s12 offen sc1
    s_add_u32 s12, s88, 8192
    buffer_load_dwordx2 v[232:233], v29, s[80:83], s12 offen sc1
    s_add_u32 s12, s88, 10240
    buffer_load_dwordx2 v[234:235], v29, s[80:83], s12 offen sc1
    s_add_u32 s12, s88, 12288
    buffer_load_dwordx2 v[236:237], v29, s[80:83], s12 offen sc1
    s_add_u32 s12, s88, 14336
    buffer_load_dwordx2 v[238:239], v29, s[80:83], s12 offen sc1
    s_add_u32 s12, s88, 16384
    buffer_load_dwordx2 v[240:241], v29, s[80:83], s12 offen sc1
    s_add_u32 s12, s88, 18432
    buffer_load_dwordx2 v[242:243], v29, s[80:83], s12 offen sc1
    buffer_load_dwordx4 v[120:123], v30, s[84:87], 0 offen sc1
    v_mfma_f32_32x32x16_bf16 v[176:191], v[52:55], v[68:71], v[176:191]
    s_waitcnt vmcnt(11) lgkmcnt(0)
    s_barrier
    v_mfma_f32_32x32x16_bf16 v[128:143], v[80:83], v[84:87], v[128:143]
    v_add_u32 v15, s76, v13
    v_add_u32 v17, s76, v14
    v_xor_b32 v16, 32, v15
    v_xor_b32 v21, 32, v17
    v_mfma_f32_32x32x16_bf16 v[144:159], v[80:83], v[88:91], v[144:159]
    ds_read_b128 v[32:35], v15
    ds_read_b128 v[36:39], v17 offset:0
    ds_read_b128 v[40:43], v17 offset:16384
    v_mfma_f32_32x32x16_bf16 v[160:175], v[80:83], v[92:95], v[160:175]
    ds_read_b128 v[44:47], v17 offset:4096
    ds_read_b128 v[48:51], v17 offset:20480
    ds_read_b128 v[52:55], v16
    v_mfma_f32_32x32x16_bf16 v[176:191], v[80:83], v[96:99], v[176:191]
    ds_read_b128 v[56:59], v21 offset:0
    ds_read_b128 v[60:63], v21 offset:16384
    ds_read_b128 v[64:67], v21 offset:4096
    v_mfma_f32_32x32x16_bf16 v[128:143], v[100:103], v[104:107], v[128:143]
    ds_read_b128 v[68:71], v21 offset:20480
    v_mfma_f32_32x32x16_bf16 v[144:159], v[100:103], v[108:111], v[144:159]
    v_mfma_f32_32x32x16_bf16 v[160:175], v[100:103], v[112:115], v[160:175]
    v_mfma_f32_32x32x16_bf16 v[176:191], v[100:103], v[116:119], v[176:191]
    s_waitcnt lgkmcnt(0)
    v_mfma_f32_32x32x16_bf16 v[128:143], v[32:35], v[36:39], v[128:143]
    v_add_u32 v15, s76, v13
    v_add_u32 v17, s76, v14
    v_xor_b32 v15, 64, v15
    v_xor_b32 v17, 64, v17
    v_xor_b32 v16, 32, v15
    v_xor_b32 v21, 32, v17
    s_add_u32 s76, s76, 49152
    s_cmp_ge_u32 s76, 147456
    s_cselect_b32 s76, 0, s76
    v_mfma_f32_32x32x16_bf16 v[144:159], v[32:35], v[40:43], v[144:159]
    ds_read_b128 v[80:83], v15
    ds_read_b128 v[84:87], v17 offset:0
    ds_read_b128 v[88:91], v17 offset:16384
    v_mfma_f32_32x32x16_bf16 v[160:175], v[32:35], v[44:47], v[160:175]
    ds_read_b128 v[92:95], v17 offset:4096
    ds_read_b128 v[96:99], v17 offset:20480
    ds_read_b128 v[100:103], v16
    v_mfma_f32_32x32x16_bf16 v[176:191], v[32:35], v[48:51], v[176:191]
    ds_read_b128 v[104:107], v21 offset:0
    ds_read_b128 v[108:111], v21 offset:16384
    ds_read_b128 v[112:115], v21 offset:4096
    v_mfma_f32_32x32x16_bf16 v[128:143], v[52:55], v[56:59], v[128:143]
    ds_read_b128 v[116:119], v21 offset:20480
    v_mfma_f32_32x32x16_bf16 v[144:159], v[52:55], v[60:63], v[144:159]
    v_mfma_f32_32x32x16_bf16 v[160:175], v[52:55], v[64:67], v[160:175]
    v_readfirstlane_b32 s10, v247
    s_cmp_lg_u32 s10, 0
    s_cbranch_scc1 K1_EN1_SE
    v_mov_b32 v3, 0
    s_mov_b32 s11, 30000
K1_EN0_SE:
    global_load_dword v247, v3, s[44:45] sc1
    s_waitcnt vmcnt(0)
    v_readfirstlane_b32 s10, v247
    s_sub_u32 s11, s11, 1
    s_cmp_eq_u32 s11, 0
    s_cbranch_scc1 K1_EN1_SE
    s_cmp_eq_u32 s10, 0
    s_cbranch_scc1 K1_EN0_SE
K1_EN1_SE:
    s_mov_b32 s77, 30000
K1S_CHK:
    s_waitcnt vmcnt(0)
    v_not_b32 v3, v247
    v_cmp_eq_u32 s[10:11], v122, v247
    v_cmp_eq_u32 vcc, v123, v3
    s_and_b64 s[10:11], s[10:11], vcc
    v_mov_b32 v4, 0x7ffffff0
    v_cmp_eq_u32 s[12:13], v4, v30
    s_or_b64 s[10:11], s[10:11], s[12:13]
    v_cmp_eq_u32 s[12:13], v4, v29
    s_mov_b64 s[14:15], -1
    v_cmp_eq_u32 vcc, v225, v247
    s_and_b64 s[14:15], s[14:15], vcc
    v_cmp_eq_u32 vcc, v227, v247
    s_and_b64 s[14:15], s[14:15], vcc
    v_cmp_eq_u32 vcc, v229, v247
    s_and_b64 s[14:15], s[14:15], vcc
    v_cmp_eq_u32 vcc, v231, v247
    s_and_b64 s[14:15], s[14:15], vcc
    v_cmp_eq_u32 vcc, v233, v247
    s_and_b64 s[14:15], s[14:15], vcc
    v_cmp_eq_u32 vcc, v235, v247
    s_and_b64 s[14:15], s[14:15], vcc
    v_cmp_eq_u32 vcc, v237, v247
    s_and_b64 s[14:15], s[14:15], vcc
    v_cmp_eq_u32 vcc, v239, v247
    s_and_b64 s[14:15], s[14:15], vcc
    v_cmp_eq_u32 vcc, v241, v247
    s_and_b64 s[14:15], s[14:15], vcc
    v_cmp_eq_u32 vcc, v243, v247
    s_and_b64 s[14:15], s[14:15], vcc
    s_or_b64 s[14:15], s[14:15], s[12:13]
    s_and_b64 s[10:11], s[10:11], s[14:15]
    s_cmp_eq_u64 s[10:11], -1
    s_cbranch_scc1 K1S_OK
    s_sub_u32 s77, s77, 1
    s_cmp_eq_u32 s77, 0
    s_cbranch_scc1 K1S_OK
    s_sleep 1
    s_add_u32 s12, s88, 0
    buffer_load_dwordx2 v[224:225], v29, s[80:83], s12 offen sc1
    s_add_u32 s12, s88, 2048
    buffer_load_dwordx2 v[226:227], v29, s[80:83], s12 offen sc1
    s_add_u32 s12, s88, 4096
    buffer_load_dwordx2 v[228:229], v29, s[80:83], s12 offen sc1
    s_add_u32 s12, s88, 6144
    buffer_load_dwordx2 v[230:231], v29, s[80:83], s12 offen sc1
    s_add_u32 s12, s88, 8192
    buffer_load_dwordx2 v[232:233], v29, s[80:83], s12 offen sc1
    s_add_u32 s12, s88, 10240
    buffer_load_dwordx2 v[234:235], v29, s[80:83], s12 offen sc1
    s_add_u32 s12, s88, 12288
    buffer_load_dwordx2 v[236:237], v29, s[80:83], s12 offen sc1
    s_add_u32 s12, s88, 14336
    buffer_load_dwordx2 v[238:239], v29, s[80:83], s12 offen sc1
    s_add_u32 s12, s88, 16384
    buffer_load_dwordx2 v[240:241], v29, s[80:83], s12 offen sc1
    s_add_u32 s12, s88, 18432
    buffer_load_dwordx2 v[242:243], v29, s[80:83], s12 offen sc1
    buffer_load_dwordx4 v[120:123], v30, s[84:87], 0 offen sc1
    s_branch K1S_CHK
K1S_OK:
    v_add_f32 v224, v224, v226
    v_add_f32 v224, v224, v228
    v_add_f32 v224, v224, v230
    v_add_f32 v224, v224, v232
    v_add_f32 v224, v224, v234
    v_add_f32 v224, v224, v236
    v_add_f32 v224, v224, v238
    v_add_f32 v224, v224, v240
    v_add_f32 v224, v224, v242
    v_mul_f32 v123, v120, v121
    v_lshlrev_b32 v4, 2, v0
    v_add_u32 v4, 147456, v4
    v_cmp_gt_u32 vcc, 256, v0
    s_and_saveexec_b64 s[10:11], vcc
    ds_write_b32 v4, v224
    s_mov_b64 exec, s[10:11]
    v_subrev_u32 v5, 256, v0
    v_cmp_gt_u32 vcc, 128, v5
    s_and_saveexec_b64 s[10:11], vcc
    ds_write_b32 v4, v121
    ds_write_b32 v4, v123 offset:512
    s_mov_b64 exec, s[10:11]
    v_mfma_f32_32x32x16_bf16 v[176:191], v[52:55], v[68:71], v[176:191]
    s_waitcnt lgkmcnt(0)
    v_mfma_f32_32x32x16_bf16 v[128:143], v[80:83], v[84:87], v[128:143]
    v_mfma_f32_32x32x16_bf16 v[144:159], v[80:83], v[88:91], v[144:159]
    v_mfma_f32_32x32x16_bf16 v[160:175], v[80:83], v[92:95], v[160:175]
    v_mfma_f32_32x32x16_bf16 v[176:191], v[80:83], v[96:99], v[176:191]
    v_mfma_f32_32x32x16_bf16 v[128:143], v[100:103], v[104:107], v[128:143]
    v_mfma_f32_32x32x16_bf16 v[144:159], v[100:103], v[108:111], v[144:159]
    v_mfma_f32_32x32x16_bf16 v[160:175], v[100:103], v[112:115], v[160:175]
    v_mfma_f32_32x32x16_bf16 v[176:191], v[100:103], v[116:119], v[176:191]
    s_branch K1S_EPI
HK_S_I:
    s_sub_u32 s13, s3, 1
    s_cmp_ge_u32 s13, 1
    s_cbranch_scc1 K1_NOW_25
    s_mov_b32 s92, s40
    s_mov_b32 s93, s41
    s_mov_b32 s94, 2211840
    s_mov_b32 s95, 0x20000
    s_mul_i32 s13, s13, 5120
    s_add_u32 s13, s13, 151872
    s_add_u32 m0, s13, 0
    s_nop 0
    buffer_load_dwordx4 v193, s[92:95], s90 offen lds
    s_add_u32 m0, s13, 1024
    s_nop 0
    buffer_load_dwordx4 v194, s[92:95], s90 offen lds
    s_add_u32 m0, s13, 2048
    s_nop 0
    buffer_load_dwordx4 v195, s[92:95], s90 offen lds
    s_add_u32 m0, s13, 3072
    s_nop 0
    buffer_load_dwordx4 v196, s[92:95], s90 offen lds
    s_add_u32 m0, s13, 4096
    s_nop 0
    buffer_load_dwordx4 v197, s[92:95], s90 offen lds
K1_NOW_25:
    s_branch HK_S_I_B
HK_S_F:
    v_lshlrev_b32 v244, 4, v2
    s_sub_u32 s13, s3, 1
    s_cmp_ge_u32 s13, 1
    s_cbranch_scc1 K1_SF2_27
    v_lshrrev_b32 v245, 5, v2
    v_lshlrev_b32 v245, 4, v245
    v_bfe_u32 v4, v2, 4, 1
    v_lshl_add_u32 v245, v4, 2, v245
    v_bfe_u32 v4, v2, 2, 2
    v_add_u32 v245, v245, v4
    v_mul_u32_u24 v245, 160, v245
    v_and_b32 v4, 3, v2
    v_lshl_add_u32 v245, v4, 3, v245
    s_mul_i32 s13, s13, 5120
    s_add_u32 s13, s13, 151872
    v_add_u32 v245, s13, v245
    ds_read_b64_tr_b16 v[224:225], v245 offset:0
    ds_read_b64_tr_b16 v[226:227], v245 offset:1280
    ds_read_b64_tr_b16 v[228:229], v245 offset:32
    ds_read_b64_tr_b16 v[230:231], v245 offset:1312
    ds_read_b64_tr_b16 v[232:233], v245 offset:64
    ds_read_b64_tr_b16 v[234:235], v245 offset:1344
    ds_read_b64_tr_b16 v[236:237], v245 offset:96
    ds_read_b64_tr_b16 v[238:239], v245 offset:1376
    ds_read_b64_tr_b16 v[240:241], v245 offset:128
    ds_read_b64_tr_b16 v[242:243], v245 offset:1408
    s_waitcnt lgkmcnt(0)
    s_add_u32 s13, s101, 0
    buffer_store_dwordx4 v[224:227], v244, s[96:99], s13 offen sc1
    s_add_u32 s13, s101, 1024
    buffer_store_dwordx4 v[228:231], v244, s[96:99], s13 offen sc1
    s_add_u32 s13, s101, 2048
    buffer_store_dwordx4 v[232:235], v244, s[96:99], s13 offen sc1
    s_add_u32 s13, s101, 3072
    buffer_store_dwordx4 v[236:239], v244, s[96:99], s13 offen sc1
    s_add_u32 s13, s101, 4096
    buffer_store_dwordx4 v[240:243], v244, s[96:99], s13 offen sc1
K1_SF2_27:
    s_branch HK_S_F_B
HK_S_A:
    s_cmp_eq_u32 s3, 0
    s_cbranch_scc0 K1_AI_CBS
    s_mov_b32 s10, 32
    v_mov_b32 v31, s10
    v_mov_b32 v27, 1
    s_mov_b64 s[12:13], exec
    s_mov_b64 exec, 1
    global_atomic_add v31, v31, v27, s[44:45] sc0 sc1
    s_mov_b64 exec, s[12:13]
K1_AI_CBS:
    s_branch HK_S_A_B
K1S_EPI:
    s_waitcnt lgkmcnt(0)
    s_barrier
    v_and_b32 v3, 31, v2
    s_lshl_b32 s10, s5, 7
    v_add_u32 v3, s10, v3
    v_lshlrev_b32 v3, 2, v3
    v_add_u32 v3, 147456, v3
    ds_read_b32 v22, v3 offset:0
    ds_read_b32 v23, v3 offset:128
    ds_read_b32 v24, v3 offset:256
    ds_read_b32 v25, v3 offset:384
    v_lshrrev_b32 v4, 5, v2
    v_lshlrev_b32 v3, 6, v4
    s_lshl_b32 s10, s4, 7
    s_add_u32 s10, s10, 148480
    v_add_u32 v3, s10, v3
    ds_read_b128 v[32:35], v3 offset:0
    ds_read_b128 v[36:39], v3 offset:16
    ds_read_b128 v[40:43], v3 offset:32
    ds_read_b128 v[44:47], v3 offset:48
    ds_read_b128 v[48:51], v3 offset:512
    ds_read_b128 v[52:55], v3 offset:528
    ds_read_b128 v[56:59], v3 offset:544
    ds_read_b128 v[60:63], v3 offset:560
    s_waitcnt lgkmcnt(0)
    v_mul_f32 v240, v210, v22
    v_fma_f32 v240, -v211, v23, v240
    v_mul_f32 v241, v210, v23
    v_fma_f32 v241, v211, v22, v241
    v_mul_f32 v242, v218, v24
    v_fma_f32 v242, -v219, v25, v242
    v_mul_f32 v243, v218, v25
    v_fma_f32 v243, v219, v24, v243
    v_pk_mul_f32 v[64:65], v[128:129], v[210:211] op_sel_hi:[1,0]
    v_pk_mul_f32 v[66:67], v[144:145], v[210:211] op_sel_hi:[1,0]
    v_pk_fma_f32 v[64:65], v[144:145], v[210:211], v[64:65] op_sel:[0,1,0] neg_lo:[0,1,0] neg_hi:[0,1,0]
    v_pk_fma_f32 v[66:67], v[128:129], v[210:211], v[66:67] op_sel:[0,1,0]
    v_pk_mul_f32 v[64:65], v[64:65], v[32:33]
    v_pk_mul_f32 v[66:67], v[66:67], v[32:33]
    v_pk_fma_f32 v[128:129], v[48:49], v[240:241], v[64:65] op_sel_hi:[1,0,1] neg_lo:[0,1,0] neg_hi:[0,1,0]
    v_pk_fma_f32 v[144:145], v[48:49], v[240:241], v[66:67] op_sel:[0,1,0] neg_lo:[0,1,0] neg_hi:[0,1,0]
    v_pk_mul_f32 v[68:69], v[160:161], v[218:219] op_sel_hi:[1,0]
    v_pk_mul_f32 v[70:71], v[176:177], v[218:219] op_sel_hi:[1,0]
    v_pk_fma_f32 v[68:69], v[176:177], v[218:219], v[68:69] op_sel:[0,1,0] neg_lo:[0,1,0] neg_hi:[0,1,0]
    v_pk_fma_f32 v[70:71], v[160:161], v[218:219], v[70:71] op_sel:[0,1,0]
    v_pk_mul_f32 v[68:69], v[68:69], v[32:33]
    v_pk_mul_f32 v[70:71], v[70:71], v[32:33]
    v_pk_fma_f32 v[160:161], v[48:49], v[242:243], v[68:69] op_sel_hi:[1,0,1] neg_lo:[0,1,0] neg_hi:[0,1,0]
    v_pk_fma_f32 v[176:177], v[48:49], v[242:243], v[70:71] op_sel:[0,1,0] neg_lo:[0,1,0] neg_hi:[0,1,0]
    v_fma_f32 v129, v208, v128, v129
    v_fma_f32 v145, v208, v144, v145
    v_fma_f32 v129, -v209, v144, v129
    v_fma_f32 v145, v209, v128, v145
    v_fma_f32 v161, v216, v160, v161
    v_fma_f32 v177, v216, v176, v177
    v_fma_f32 v161, -v217, v176, v161
    v_fma_f32 v177, v217, v160, v177
    v_pk_mul_f32 v[64:65], v[130:131], v[210:211] op_sel_hi:[1,0]
    v_pk_mul_f32 v[66:67], v[146:147], v[210:211] op_sel_hi:[1,0]
    v_pk_fma_f32 v[64:65], v[146:147], v[210:211], v[64:65] op_sel:[0,1,0] neg_lo:[0,1,0] neg_hi:[0,1,0]
    v_pk_fma_f32 v[66:67], v[130:131], v[210:211], v[66:67] op_sel:[0,1,0]
    v_pk_mul_f32 v[64:65], v[64:65], v[34:35]
    v_pk_mul_f32 v[66:67], v[66:67], v[34:35]
    v_pk_fma_f32 v[130:131], v[50:51], v[240:241], v[64:65] op_sel_hi:[1,0,1] neg_lo:[0,1,0] neg_hi:[0,1,0]
    v_pk_fma_f32 v[146:147], v[50:51], v[240:241], v[66:67] op_sel:[0,1,0] neg_lo:[0,1,0] neg_hi:[0,1,0]
    v_pk_mul_f32 v[68:69], v[162:163], v[218:219] op_sel_hi:[1,0]
    v_pk_mul_f32 v[70:71], v[178:179], v[218:219] op_sel_hi:[1,0]
    v_pk_fma_f32 v[68:69], v[178:179], v[218:219], v[68:69] op_sel:[0,1,0] neg_lo:[0,1,0] neg_hi:[0,1,0]
    v_pk_fma_f32 v[70:71], v[162:163], v[218:219], v[70:71] op_sel:[0,1,0]
    v_pk_mul_f32 v[68:69], v[68:69], v[34:35]
    v_pk_mul_f32 v[70:71], v[70:71], v[34:35]
    v_pk_fma_f32 v[162:163], v[50:51], v[242:243], v[68:69] op_sel_hi:[1,0,1] neg_lo:[0,1,0] neg_hi:[0,1,0]
    v_pk_fma_f32 v[178:179], v[50:51], v[242:243], v[70:71] op_sel:[0,1,0] neg_lo:[0,1,0] neg_hi:[0,1,0]
    v_fma_f32 v130, v208, v129, v130
    v_fma_f32 v146, v208, v145, v146
    v_fma_f32 v130, -v209, v145, v130
    v_fma_f32 v146, v209, v129, v146
    v_fma_f32 v162, v216, v161, v162
    v_fma_f32 v178, v216, v177, v178
    v_fma_f32 v162, -v217, v177, v162
    v_fma_f32 v178, v217, v161, v178
    v_fma_f32 v131, v208, v130, v131
    v_fma_f32 v147, v208, v146, v147
    v_fma_f32 v131, -v209, v146, v131
    v_fma_f32 v147, v209, v130, v147
    v_fma_f32 v163, v216, v162, v163
    v_fma_f32 v179, v216, v178, v179
    v_fma_f32 v163, -v217, v178, v163
    v_fma_f32 v179, v217, v162, v179
    v_pk_mul_f32 v[64:65], v[132:133], v[210:211] op_sel_hi:[1,0]
    v_pk_mul_f32 v[66:67], v[148:149], v[210:211] op_sel_hi:[1,0]
    v_pk_fma_f32 v[64:65], v[148:149], v[210:211], v[64:65] op_sel:[0,1,0] neg_lo:[0,1,0] neg_hi:[0,1,0]
    v_pk_fma_f32 v[66:67], v[132:133], v[210:211], v[66:67] op_sel:[0,1,0]
    v_pk_mul_f32 v[64:65], v[64:65], v[36:37]
    v_pk_mul_f32 v[66:67], v[66:67], v[36:37]
    v_pk_fma_f32 v[132:133], v[52:53], v[240:241], v[64:65] op_sel_hi:[1,0,1] neg_lo:[0,1,0] neg_hi:[0,1,0]
    v_pk_fma_f32 v[148:149], v[52:53], v[240:241], v[66:67] op_sel:[0,1,0] neg_lo:[0,1,0] neg_hi:[0,1,0]
    v_pk_mul_f32 v[68:69], v[164:165], v[218:219] op_sel_hi:[1,0]
    v_pk_mul_f32 v[70:71], v[180:181], v[218:219] op_sel_hi:[1,0]
    v_pk_fma_f32 v[68:69], v[180:181], v[218:219], v[68:69] op_sel:[0,1,0] neg_lo:[0,1,0] neg_hi:[0,1,0]
    v_pk_fma_f32 v[70:71], v[164:165], v[218:219], v[70:71] op_sel:[0,1,0]
    v_pk_mul_f32 v[68:69], v[68:69], v[36:37]
    v_pk_mul_f32 v[70:71], v[70:71], v[36:37]
    v_pk_fma_f32 v[164:165], v[52:53], v[242:243], v[68:69] op_sel_hi:[1,0,1] neg_lo:[0,1,0] neg_hi:[0,1,0]
    v_pk_fma_f32 v[180:181], v[52:53], v[242:243], v[70:71] op_sel:[0,1,0] neg_lo:[0,1,0] neg_hi:[0,1,0]
    v_fma_f32 v132, v208, v131, v132
    v_fma_f32 v148, v208, v147, v148
    v_fma_f32 v132, -v209, v147, v132
    v_fma_f32 v148, v209, v131, v148
    v_fma_f32 v164, v216, v163, v164
    v_fma_f32 v180, v216, v179, v180
    v_fma_f32 v164, -v217, v179, v164
    v_fma_f32 v180, v217, v163, v180
    v_fma_f32 v133, v208, v132, v133
    v_fma_f32 v149, v208, v148, v149
    v_fma_f32 v133, -v209, v148, v133
    v_fma_f32 v149, v209, v132, v149
    v_fma_f32 v165, v216, v164, v165
    v_fma_f32 v181, v216, v180, v181
    v_fma_f32 v165, -v217, v180, v165
    v_fma_f32 v181, v217, v164, v181
    v_pk_mul_f32 v[64:65], v[134:135], v[210:211] op_sel_hi:[1,0]
    v_pk_mul_f32 v[66:67], v[150:151], v[210:211] op_sel_hi:[1,0]
    v_pk_fma_f32 v[64:65], v[150:151], v[210:211], v[64:65] op_sel:[0,1,0] neg_lo:[0,1,0] neg_hi:[0,1,0]
    v_pk_fma_f32 v[66:67], v[134:135], v[210:211], v[66:67] op_sel:[0,1,0]
    v_pk_mul_f32 v[64:65], v[64:65], v[38:39]
    v_pk_mul_f32 v[66:67], v[66:67], v[38:39]
    v_pk_fma_f32 v[134:135], v[54:55], v[240:241], v[64:65] op_sel_hi:[1,0,1] neg_lo:[0,1,0] neg_hi:[0,1,0]
    v_pk_fma_f32 v[150:151], v[54:55], v[240:241], v[66:67] op_sel:[0,1,0] neg_lo:[0,1,0] neg_hi:[0,1,0]
    v_pk_mul_f32 v[68:69], v[166:167], v[218:219] op_sel_hi:[1,0]
    v_pk_mul_f32 v[70:71], v[182:183], v[218:219] op_sel_hi:[1,0]
    v_pk_fma_f32 v[68:69], v[182:183], v[218:219], v[68:69] op_sel:[0,1,0] neg_lo:[0,1,0] neg_hi:[0,1,0]
    v_pk_fma_f32 v[70:71], v[166:167], v[218:219], v[70:71] op_sel:[0,1,0]
    v_pk_mul_f32 v[68:69], v[68:69], v[38:39]
    v_pk_mul_f32 v[70:71], v[70:71], v[38:39]
    v_pk_fma_f32 v[166:167], v[54:55], v[242:243], v[68:69] op_sel_hi:[1,0,1] neg_lo:[0,1,0] neg_hi:[0,1,0]
    v_pk_fma_f32 v[182:183], v[54:55], v[242:243], v[70:71] op_sel:[0,1,0] neg_lo:[0,1,0] neg_hi:[0,1,0]
    v_fma_f32 v134, v208, v133, v134
    v_fma_f32 v150, v208, v149, v150
    v_fma_f32 v134, -v209, v149, v134
    v_fma_f32 v150, v209, v133, v150
    v_fma_f32 v166, v216, v165, v166
    v_fma_f32 v182, v216, v181, v182
    v_fma_f32 v166, -v217, v181, v166
    v_fma_f32 v182, v217, v165, v182
    v_fma_f32 v135, v208, v134, v135
    v_fma_f32 v151, v208, v150, v151
    v_fma_f32 v135, -v209, v150, v135
    v_fma_f32 v151, v209, v134, v151
    v_fma_f32 v167, v216, v166, v167
    v_fma_f32 v183, v216, v182, v183
    v_fma_f32 v167, -v217, v182, v167
    v_fma_f32 v183, v217, v166, v183
    v_pk_mul_f32 v[64:65], v[136:137], v[210:211] op_sel_hi:[1,0]
    v_pk_mul_f32 v[66:67], v[152:153], v[210:211] op_sel_hi:[1,0]
    v_pk_fma_f32 v[64:65], v[152:153], v[210:211], v[64:65] op_sel:[0,1,0] neg_lo:[0,1,0] neg_hi:[0,1,0]
    v_pk_fma_f32 v[66:67], v[136:137], v[210:211], v[66:67] op_sel:[0,1,0]
    v_pk_mul_f32 v[64:65], v[64:65], v[40:41]
    v_pk_mul_f32 v[66:67], v[66:67], v[40:41]
    v_pk_fma_f32 v[136:137], v[56:57], v[240:241], v[64:65] op_sel_hi:[1,0,1] neg_lo:[0,1,0] neg_hi:[0,1,0]
    v_pk_fma_f32 v[152:153], v[56:57], v[240:241], v[66:67] op_sel:[0,1,0] neg_lo:[0,1,0] neg_hi:[0,1,0]
    v_pk_mul_f32 v[68:69], v[168:169], v[218:219] op_sel_hi:[1,0]
    v_pk_mul_f32 v[70:71], v[184:185], v[218:219] op_sel_hi:[1,0]
    v_pk_fma_f32 v[68:69], v[184:185], v[218:219], v[68:69] op_sel:[0,1,0] neg_lo:[0,1,0] neg_hi:[0,1,0]
    v_pk_fma_f32 v[70:71], v[168:169], v[218:219], v[70:71] op_sel:[0,1,0]
    v_pk_mul_f32 v[68:69], v[68:69], v[40:41]
    v_pk_mul_f32 v[70:71], v[70:71], v[40:41]
    v_pk_fma_f32 v[168:169], v[56:57], v[242:243], v[68:69] op_sel_hi:[1,0,1] neg_lo:[0,1,0] neg_hi:[0,1,0]
    v_pk_fma_f32 v[184:185], v[56:57], v[242:243], v[70:71] op_sel:[0,1,0] neg_lo:[0,1,0] neg_hi:[0,1,0]
    v_fma_f32 v136, v208, v135, v136
    v_fma_f32 v152, v208, v151, v152
    v_fma_f32 v136, -v209, v151, v136
    v_fma_f32 v152, v209, v135, v152
    v_fma_f32 v168, v216, v167, v168
    v_fma_f32 v184, v216, v183, v184
    v_fma_f32 v168, -v217, v183, v168
    v_fma_f32 v184, v217, v167, v184
    v_fma_f32 v137, v208, v136, v137
    v_fma_f32 v153, v208, v152, v153
    v_fma_f32 v137, -v209, v152, v137
    v_fma_f32 v153, v209, v136, v153
    v_fma_f32 v169, v216, v168, v169
    v_fma_f32 v185, v216, v184, v185
    v_fma_f32 v169, -v217, v184, v169
    v_fma_f32 v185, v217, v168, v185
    v_pk_mul_f32 v[64:65], v[138:139], v[210:211] op_sel_hi:[1,0]
    v_pk_mul_f32 v[66:67], v[154:155], v[210:211] op_sel_hi:[1,0]
    v_pk_fma_f32 v[64:65], v[154:155], v[210:211], v[64:65] op_sel:[0,1,0] neg_lo:[0,1,0] neg_hi:[0,1,0]
    v_pk_fma_f32 v[66:67], v[138:139], v[210:211], v[66:67] op_sel:[0,1,0]
    v_pk_mul_f32 v[64:65], v[64:65], v[42:43]
    v_pk_mul_f32 v[66:67], v[66:67], v[42:43]
    v_pk_fma_f32 v[138:139], v[58:59], v[240:241], v[64:65] op_sel_hi:[1,0,1] neg_lo:[0,1,0] neg_hi:[0,1,0]
    v_pk_fma_f32 v[154:155], v[58:59], v[240:241], v[66:67] op_sel:[0,1,0] neg_lo:[0,1,0] neg_hi:[0,1,0]
    v_pk_mul_f32 v[68:69], v[170:171], v[218:219] op_sel_hi:[1,0]
    v_pk_mul_f32 v[70:71], v[186:187], v[218:219] op_sel_hi:[1,0]
    v_pk_fma_f32 v[68:69], v[186:187], v[218:219], v[68:69] op_sel:[0,1,0] neg_lo:[0,1,0] neg_hi:[0,1,0]
    v_pk_fma_f32 v[70:71], v[170:171], v[218:219], v[70:71] op_sel:[0,1,0]
    v_pk_mul_f32 v[68:69], v[68:69], v[42:43]
    v_pk_mul_f32 v[70:71], v[70:71], v[42:43]
    v_pk_fma_f32 v[170:171], v[58:59], v[242:243], v[68:69] op_sel_hi:[1,0,1] neg_lo:[0,1,0] neg_hi:[0,1,0]
    v_pk_fma_f32 v[186:187], v[58:59], v[242:243], v[70:71] op_sel:[0,1,0] neg_lo:[0,1,0] neg_hi:[0,1,0]
    v_fma_f32 v138, v208, v137, v138
    v_fma_f32 v154, v208, v153, v154
    v_fma_f32 v138, -v209, v153, v138
    v_fma_f32 v154, v209, v137, v154
    v_fma_f32 v170, v216, v169, v170
    v_fma_f32 v186, v216, v185, v186
    v_fma_f32 v170, -v217, v185, v170
    v_fma_f32 v186, v217, v169, v186
    v_fma_f32 v139, v208, v138, v139
    v_fma_f32 v155, v208, v154, v155
    v_fma_f32 v139, -v209, v154, v139
    v_fma_f32 v155, v209, v138, v155
    v_fma_f32 v171, v216, v170, v171
    v_fma_f32 v187, v216, v186, v187
    v_fma_f32 v171, -v217, v186, v171
    v_fma_f32 v187, v217, v170, v187
    v_pk_mul_f32 v[64:65], v[140:141], v[210:211] op_sel_hi:[1,0]
    v_pk_mul_f32 v[66:67], v[156:157], v[210:211] op_sel_hi:[1,0]
    v_pk_fma_f32 v[64:65], v[156:157], v[210:211], v[64:65] op_sel:[0,1,0] neg_lo:[0,1,0] neg_hi:[0,1,0]
    v_pk_fma_f32 v[66:67], v[140:141], v[210:211], v[66:67] op_sel:[0,1,0]
    v_pk_mul_f32 v[64:65], v[64:65], v[44:45]
    v_pk_mul_f32 v[66:67], v[66:67], v[44:45]
    v_pk_fma_f32 v[140:141], v[60:61], v[240:241], v[64:65] op_sel_hi:[1,0,1] neg_lo:[0,1,0] neg_hi:[0,1,0]
    v_pk_fma_f32 v[156:157], v[60:61], v[240:241], v[66:67] op_sel:[0,1,0] neg_lo:[0,1,0] neg_hi:[0,1,0]
    v_pk_mul_f32 v[68:69], v[172:173], v[218:219] op_sel_hi:[1,0]
    v_pk_mul_f32 v[70:71], v[188:189], v[218:219] op_sel_hi:[1,0]
    v_pk_fma_f32 v[68:69], v[188:189], v[218:219], v[68:69] op_sel:[0,1,0] neg_lo:[0,1,0] neg_hi:[0,1,0]
    v_pk_fma_f32 v[70:71], v[172:173], v[218:219], v[70:71] op_sel:[0,1,0]
    v_pk_mul_f32 v[68:69], v[68:69], v[44:45]
    v_pk_mul_f32 v[70:71], v[70:71], v[44:45]
    v_pk_fma_f32 v[172:173], v[60:61], v[242:243], v[68:69] op_sel_hi:[1,0,1] neg_lo:[0,1,0] neg_hi:[0,1,0]
    v_pk_fma_f32 v[188:189], v[60:61], v[242:243], v[70:71] op_sel:[0,1,0] neg_lo:[0,1,0] neg_hi:[0,1,0]
    v_fma_f32 v140, v208, v139, v140
    v_fma_f32 v156, v208, v155, v156
    v_fma_f32 v140, -v209, v155, v140
    v_fma_f32 v156, v209, v139, v156
    v_fma_f32 v172, v216, v171, v172
    v_fma_f32 v188, v216, v187, v188
    v_fma_f32 v172, -v217, v187, v172
    v_fma_f32 v188, v217, v171, v188
    v_fma_f32 v141, v208, v140, v141
    v_fma_f32 v157, v208, v156, v157
    v_fma_f32 v141, -v209, v156, v141
    v_fma_f32 v157, v209, v140, v157
    v_fma_f32 v173, v216, v172, v173
    v_fma_f32 v189, v216, v188, v189
    v_fma_f32 v173, -v217, v188, v173
    v_fma_f32 v189, v217, v172, v189
    v_pk_mul_f32 v[64:65], v[142:143], v[210:211] op_sel_hi:[1,0]
    v_pk_mul_f32 v[66:67], v[158:159], v[210:211] op_sel_hi:[1,0]
    v_pk_fma_f32 v[64:65], v[158:159], v[210:211], v[64:65] op_sel:[0,1,0] neg_lo:[0,1,0] neg_hi:[0,1,0]
    v_pk_fma_f32 v[66:67], v[142:143], v[210:211], v[66:67] op_sel:[0,1,0]
    v_pk_mul_f32 v[64:65], v[64:65], v[46:47]
    v_pk_mul_f32 v[66:67], v[66:67], v[46:47]
    v_pk_fma_f32 v[142:143], v[62:63], v[240:241], v[64:65] op_sel_hi:[1,0,1] neg_lo:[0,1,0] neg_hi:[0,1,0]
    v_pk_fma_f32 v[158:159], v[62:63], v[240:241], v[66:67] op_sel:[0,1,0] neg_lo:[0,1,0] neg_hi:[0,1,0]
    v_pk_mul_f32 v[68:69], v[174:175], v[218:219] op_sel_hi:[1,0]
    v_pk_mul_f32 v[70:71], v[190:191], v[218:219] op_sel_hi:[1,0]
    v_pk_fma_f32 v[68:69], v[190:191], v[218:219], v[68:69] op_sel:[0,1,0] neg_lo:[0,1,0] neg_hi:[0,1,0]
    v_pk_fma_f32 v[70:71], v[174:175], v[218:219], v[70:71] op_sel:[0,1,0]
    v_pk_mul_f32 v[68:69], v[68:69], v[46:47]
    v_pk_mul_f32 v[70:71], v[70:71], v[46:47]
    v_pk_fma_f32 v[174:175], v[62:63], v[242:243], v[68:69] op_sel_hi:[1,0,1] neg_lo:[0,1,0] neg_hi:[0,1,0]
    v_pk_fma_f32 v[190:191], v[62:63], v[242:243], v[70:71] op_sel:[0,1,0] neg_lo:[0,1,0] neg_hi:[0,1,0]
    v_fma_f32 v142, v208, v141, v142
    v_fma_f32 v158, v208, v157, v158
    v_fma_f32 v142, -v209, v157, v142
    v_fma_f32 v158, v209, v141, v158
    v_fma_f32 v174, v216, v173, v174
    v_fma_f32 v190, v216, v189, v190
    v_fma_f32 v174, -v217, v189, v174
    v_fma_f32 v190, v217, v173, v190
    v_fma_f32 v143, v208, v142, v143
    v_fma_f32 v159, v208, v158, v159
    v_fma_f32 v143, -v209, v158, v143
    v_fma_f32 v159, v209, v142, v159
    v_fma_f32 v175, v216, v174, v175
    v_fma_f32 v191, v216, v190, v191
    v_fma_f32 v175, -v217, v190, v175
    v_fma_f32 v191, v217, v174, v191
    v_mov_b32 v228, v143
    v_mov_b32 v229, v159
    v_mov_b32 v230, v175
    v_mov_b32 v231, v191
    v_lshrrev_b32 v4, 5, v2
    s_lshl_b32 s10, s4, 1
    v_add_u32 v21, s10, v4
    v_and_b32 v3, 31, v2
    s_lshl_b32 s10, s5, 6
    v_add_u32 v3, s10, v3
    v_lshlrev_b32 v22, 3, v3
    v_lshl_add_u32 v23, v21, 10, v22
    ds_write_b64 v23, v[228:229] offset:8192
    ds_write_b64 v23, v[230:231] offset:8448
    s_waitcnt lgkmcnt(0)
    s_barrier
    ds_read_b64 v[32:33], v22 offset:8192
    ds_read_b64 v[34:35], v22 offset:9216
    ds_read_b64 v[36:37], v22 offset:10240
    ds_read_b64 v[38:39], v22 offset:11264
    ds_read_b64 v[40:41], v22 offset:12288
    ds_read_b64 v[42:43], v22 offset:13312
    ds_read_b64 v[44:45], v22 offset:14336
    ds_read_b64 v[48:49], v22 offset:8448
    ds_read_b64 v[50:51], v22 offset:9472
    ds_read_b64 v[52:53], v22 offset:10496
    ds_read_b64 v[54:55], v22 offset:11520
    ds_read_b64 v[56:57], v22 offset:12544
    ds_read_b64 v[58:59], v22 offset:13568
    ds_read_b64 v[60:61], v22 offset:14592
    v_mov_b32 v232, 0
    v_mov_b32 v233, 0
    v_mov_b32 v234, 0
    v_mov_b32 v235, 0
    s_waitcnt lgkmcnt(0)
    s_cmp_lt_u32 s4, 0
    s_cbranch_scc1 K1S_HP_DONE
    s_cmp_eq_u32 s4, 0
    s_cselect_b32 exec_lo, 0, -1
    v_fma_f32 v32, v212, v232, v32
    v_fma_f32 v33, v212, v233, v33
    v_fma_f32 v32, -v213, v233, v32
    v_fma_f32 v233, v213, v232, v33
    v_mov_b32 v232, v32
    v_fma_f32 v48, v220, v234, v48
    v_fma_f32 v49, v220, v235, v49
    v_fma_f32 v48, -v221, v235, v48
    v_fma_f32 v235, v221, v234, v49
    v_mov_b32 v234, v48
    s_cmp_le_u32 s4, 0
    s_cbranch_scc1 K1S_HP_DONE
    v_fma_f32 v34, v212, v232, v34
    v_fma_f32 v35, v212, v233, v35
    v_fma_f32 v34, -v213, v233, v34
    v_fma_f32 v233, v213, v232, v35
    v_mov_b32 v232, v34
    v_fma_f32 v50, v220, v234, v50
    v_fma_f32 v51, v220, v235, v51
    v_fma_f32 v50, -v221, v235, v50
    v_fma_f32 v235, v221, v234, v51
    v_mov_b32 v234, v50
    s_cmp_lt_u32 s4, 1
    s_cbranch_scc1 K1S_HP_DONE
    s_cmp_eq_u32 s4, 1
    s_cselect_b32 exec_lo, 0, -1
    v_fma_f32 v36, v212, v232, v36
    v_fma_f32 v37, v212, v233, v37
    v_fma_f32 v36, -v213, v233, v36
    v_fma_f32 v233, v213, v232, v37
    v_mov_b32 v232, v36
    v_fma_f32 v52, v220, v234, v52
    v_fma_f32 v53, v220, v235, v53
    v_fma_f32 v52, -v221, v235, v52
    v_fma_f32 v235, v221, v234, v53
    v_mov_b32 v234, v52
    s_cmp_le_u32 s4, 1
    s_cbranch_scc1 K1S_HP_DONE
    v_fma_f32 v38, v212, v232, v38
    v_fma_f32 v39, v212, v233, v39
    v_fma_f32 v38, -v213, v233, v38
    v_fma_f32 v233, v213, v232, v39
    v_mov_b32 v232, v38
    v_fma_f32 v54, v220, v234, v54
    v_fma_f32 v55, v220, v235, v55
    v_fma_f32 v54, -v221, v235, v54
    v_fma_f32 v235, v221, v234, v55
    v_mov_b32 v234, v54
    s_cmp_lt_u32 s4, 2
    s_cbranch_scc1 K1S_HP_DONE
    s_cmp_eq_u32 s4, 2
    s_cselect_b32 exec_lo, 0, -1
    v_fma_f32 v40, v212, v232, v40
    v_fma_f32 v41, v212, v233, v41
    v_fma_f32 v40, -v213, v233, v40
    v_fma_f32 v233, v213, v232, v41
    v_mov_b32 v232, v40
    v_fma_f32 v56, v220, v234, v56
    v_fma_f32 v57, v220, v235, v57
    v_fma_f32 v56, -v221, v235, v56
    v_fma_f32 v235, v221, v234, v57
    v_mov_b32 v234, v56
    s_cmp_le_u32 s4, 2
    s_cbranch_scc1 K1S_HP_DONE
    v_fma_f32 v42, v212, v232, v42
    v_fma_f32 v43, v212, v233, v43
    v_fma_f32 v42, -v213, v233, v42
    v_fma_f32 v233, v213, v232, v43
    v_mov_b32 v232, v42
    v_fma_f32 v58, v220, v234, v58
    v_fma_f32 v59, v220, v235, v59
    v_fma_f32 v58, -v221, v235, v58
    v_fma_f32 v235, v221, v234, v59
    v_mov_b32 v234, v58
    s_cmp_lt_u32 s4, 3
    s_cbranch_scc1 K1S_HP_DONE
    s_cmp_eq_u32 s4, 3
    s_cselect_b32 exec_lo, 0, -1
    v_fma_f32 v44, v212, v232, v44
    v_fma_f32 v45, v212, v233, v45
    v_fma_f32 v44, -v213, v233, v44
    v_fma_f32 v233, v213, v232, v45
    v_mov_b32 v232, v44
    v_fma_f32 v60, v220, v234, v60
    v_fma_f32 v61, v220, v235, v61
    v_fma_f32 v60, -v221, v235, v60
    v_fma_f32 v235, v221, v234, v61
    v_mov_b32 v234, v60
K1S_HP_DONE:
    s_mov_b64 exec, -1
    s_add_u32 s80, s46, 29360128
    s_addc_u32 s81, s47, 0
    s_mov_b32 s82, 163840
    s_mov_b32 s83, 0x20000
    s_cmp_eq_u32 s4, 3
    s_cbranch_scc0 K1S_NOPUB
    v_fma_f32 v64, v212, v232, v228
    v_fma_f32 v65, v212, v233, v229
    v_fma_f32 v64, -v213, v233, v64
    v_fma_f32 v65, v213, v232, v65
    v_mov_b32 v66, v247
    v_not_b32 v67, v247
    v_fma_f32 v68, v220, v234, v230
    v_fma_f32 v69, v220, v235, v231
    v_fma_f32 v68, -v221, v235, v68
    v_fma_f32 v69, v221, v234, v69
    v_mov_b32 v70, v247
    v_not_b32 v71, v247
    v_lshlrev_b32 v24, 3, v7
    s_mul_i32 s10, s6, 10240
    s_mov_b32 exec_lo, 0
    buffer_store_dwordx4 v[64:67], v24, s[80:83], s10 offen offset:0 sc1
    buffer_store_dwordx4 v[68:71], v24, s[80:83], s10 offen offset:512 sc1
    s_mov_b64 exec, -1
    s_nop 1
K1S_NOPUB:
    s_lshr_b32 s10, s2, 3
    s_lshl_b32 s10, s10, 7
    s_add_u32 s10, s10, 32505856
    v_mov_b32 v1, s10
    global_load_dword v1, v1, s[46:47] sc1
    s_cmp_eq_u32 s4, 0
    s_cbranch_scc0 K1S_NP1
    v_add_u32 v24, s68, v2
    v_lshlrev_b32 v24, 4, v24
    s_cmp_le_u32 s6, 0
    s_cbranch_scc1 K1S_LD0
    s_mov_b32 s10, 0
    buffer_load_dwordx4 v[96:99], v24, s[80:83], s10 offen sc1
    s_cmp_le_u32 s6, 1
    s_cbranch_scc1 K1S_LD0
    s_mov_b32 s10, 10240
    buffer_load_dwordx4 v[100:103], v24, s[80:83], s10 offen sc1
    s_cmp_le_u32 s6, 2
    s_cbranch_scc1 K1S_LD0
    s_mov_b32 s10, 20480
    buffer_load_dwordx4 v[104:107], v24, s[80:83], s10 offen sc1
    s_cmp_le_u32 s6, 3
    s_cbranch_scc1 K1S_LD0
    s_mov_b32 s10, 30720
    buffer_load_dwordx4 v[108:111], v24, s[80:83], s10 offen sc1
    s_cmp_le_u32 s6, 4
    s_cbranch_scc1 K1S_LD0
    s_mov_b32 s10, 40960
    buffer_load_dwordx4 v[112:115], v24, s[80:83], s10 offen sc1
    s_cmp_le_u32 s6, 5
    s_cbranch_scc1 K1S_LD0
    s_mov_b32 s10, 51200
    buffer_load_dwordx4 v[116:119], v24, s[80:83], s10 offen sc1
    s_cmp_le_u32 s6, 6
    s_cbranch_scc1 K1S_LD0
    s_mov_b32 s10, 61440
    buffer_load_dwordx4 v[120:123], v24, s[80:83], s10 offen sc1
    s_cmp_le_u32 s6, 7
    s_cbranch_scc1 K1S_LD0
    s_mov_b32 s10, 71680
    buffer_load_dwordx4 v[124:127], v24, s[80:83], s10 offen sc1
    s_cmp_le_u32 s6, 8
    s_cbranch_scc1 K1S_LD0
    s_mov_b32 s10, 81920
    buffer_load_dwordx4 v[192:195], v24, s[80:83], s10 offen sc1
    s_cmp_le_u32 s6, 9
    s_cbranch_scc1 K1S_LD0
    s_mov_b32 s10, 92160
    buffer_load_dwordx4 v[196:199], v24, s[80:83], s10 offen sc1
    s_cmp_le_u32 s6, 10
    s_cbranch_scc1 K1S_LD0
    s_mov_b32 s10, 102400
    buffer_load_dwordx4 v[200:203], v24, s[80:83], s10 offen sc1
    s_cmp_le_u32 s6, 11
    s_cbranch_scc1 K1S_LD0
    s_mov_b32 s10, 112640
    buffer_load_dwordx4 v[204:207], v24, s[80:83], s10 offen sc1
    s_cmp_le_u32 s6, 12
    s_cbranch_scc1 K1S_LD0
    s_mov_b32 s10, 122880
    buffer_load_dwordx4 v[224:227], v24, s[80:83], s10 offen sc1
    s_cmp_le_u32 s6, 13
    s_cbranch_scc1 K1S_LD0
    s_mov_b32 s10, 133120
    buffer_load_dwordx4 v[228:231], v24, s[80:83], s10 offen sc1
    s_cmp_le_u32 s6, 14
    s_cbranch_scc1 K1S_LD0
    s_mov_b32 s10, 143360
    buffer_load_dwordx4 v[8:11], v24, s[80:83], s10 offen sc1
K1S_LD0:
K1S_NP1:
    v_mov_b32 v32, v208
    v_mov_b32 v48, v209
    v_mov_b32 v64, v216
    v_mov_b32 v80, v217
    v_mul_f32 v33, v208, v32
    v_mul_f32 v49, v208, v48
    v_fma_f32 v33, -v209, v48, v33
    v_fma_f32 v49, v209, v32, v49
    v_mul_f32 v65, v216, v64
    v_mul_f32 v81, v216, v80
    v_fma_f32 v65, -v217, v80, v65
    v_fma_f32 v81, v217, v64, v81
    v_mul_f32 v34, v208, v33
    v_mul_f32 v50, v208, v49
    v_fma_f32 v34, -v209, v49, v34
    v_fma_f32 v50, v209, v33, v50
    v_mul_f32 v66, v216, v65
    v_mul_f32 v82, v216, v81
    v_fma_f32 v66, -v217, v81, v66
    v_fma_f32 v82, v217, v65, v82
    v_mul_f32 v35, v208, v34
    v_mul_f32 v51, v208, v50
    v_fma_f32 v35, -v209, v50, v35
    v_fma_f32 v51, v209, v34, v51
    v_mul_f32 v67, v216, v66
    v_mul_f32 v83, v216, v82
    v_fma_f32 v67, -v217, v82, v67
    v_fma_f32 v83, v217, v66, v83
    v_mul_f32 v36, v208, v35
    v_mul_f32 v52, v208, v51
    v_fma_f32 v36, -v209, v51, v36
    v_fma_f32 v52, v209, v35, v52
    v_mul_f32 v68, v216, v67
    v_mul_f32 v84, v216, v83
    v_fma_f32 v68, -v217, v83, v68
    v_fma_f32 v84, v217, v67, v84
    v_mul_f32 v37, v208, v36
    v_mul_f32 v53, v208, v52
    v_fma_f32 v37, -v209, v52, v37
    v_fma_f32 v53, v209, v36, v53
    v_mul_f32 v69, v216, v68
    v_mul_f32 v85, v216, v84
    v_fma_f32 v69, -v217, v84, v69
    v_fma_f32 v85, v217, v68, v85
    v_mul_f32 v38, v208, v37
    v_mul_f32 v54, v208, v53
    v_fma_f32 v38, -v209, v53, v38
    v_fma_f32 v54, v209, v37, v54
    v_mul_f32 v70, v216, v69
    v_mul_f32 v86, v216, v85
    v_fma_f32 v70, -v217, v85, v70
    v_fma_f32 v86, v217, v69, v86
    v_mul_f32 v39, v208, v38
    v_mul_f32 v55, v208, v54
    v_fma_f32 v39, -v209, v54, v39
    v_fma_f32 v55, v209, v38, v55
    v_mul_f32 v71, v216, v70
    v_mul_f32 v87, v216, v86
    v_fma_f32 v71, -v217, v86, v71
    v_fma_f32 v87, v217, v70, v87
    v_mul_f32 v40, v208, v39
    v_mul_f32 v56, v208, v55
    v_fma_f32 v40, -v209, v55, v40
    v_fma_f32 v56, v209, v39, v56
    v_mul_f32 v72, v216, v71
    v_mul_f32 v88, v216, v87
    v_fma_f32 v72, -v217, v87, v72
    v_fma_f32 v88, v217, v71, v88
    v_mul_f32 v41, v208, v40
    v_mul_f32 v57, v208, v56
    v_fma_f32 v41, -v209, v56, v41
    v_fma_f32 v57, v209, v40, v57
    v_mul_f32 v73, v216, v72
    v_mul_f32 v89, v216, v88
    v_fma_f32 v73, -v217, v88, v73
    v_fma_f32 v89, v217, v72, v89
    v_mul_f32 v42, v208, v41
    v_mul_f32 v58, v208, v57
    v_fma_f32 v42, -v209, v57, v42
    v_fma_f32 v58, v209, v41, v58
    v_mul_f32 v74, v216, v73
    v_mul_f32 v90, v216, v89
    v_fma_f32 v74, -v217, v89, v74
    v_fma_f32 v90, v217, v73, v90
    v_mul_f32 v43, v208, v42
    v_mul_f32 v59, v208, v58
    v_fma_f32 v43, -v209, v58, v43
    v_fma_f32 v59, v209, v42, v59
    v_mul_f32 v75, v216, v74
    v_mul_f32 v91, v216, v90
    v_fma_f32 v75, -v217, v90, v75
    v_fma_f32 v91, v217, v74, v91
    v_mul_f32 v44, v208, v43
    v_mul_f32 v60, v208, v59
    v_fma_f32 v44, -v209, v59, v44
    v_fma_f32 v60, v209, v43, v60
    v_mul_f32 v76, v216, v75
    v_mul_f32 v92, v216, v91
    v_fma_f32 v76, -v217, v91, v76
    v_fma_f32 v92, v217, v75, v92
    v_mul_f32 v45, v208, v44
    v_mul_f32 v61, v208, v60
    v_fma_f32 v45, -v209, v60, v45
    v_fma_f32 v61, v209, v44, v61
    v_mul_f32 v77, v216, v76
    v_mul_f32 v93, v216, v92
    v_fma_f32 v77, -v217, v92, v77
    v_fma_f32 v93, v217, v76, v93
    v_mul_f32 v46, v208, v45
    v_mul_f32 v62, v208, v61
    v_fma_f32 v46, -v209, v61, v46
    v_fma_f32 v62, v209, v45, v62
    v_mul_f32 v78, v216, v77
    v_mul_f32 v94, v216, v93
    v_fma_f32 v78, -v217, v93, v78
    v_fma_f32 v94, v217, v77, v94
    v_mul_f32 v47, v208, v46
    v_mul_f32 v63, v208, v62
    v_fma_f32 v47, -v209, v62, v47
    v_fma_f32 v63, v209, v46, v63
    v_mul_f32 v79, v216, v78
    v_mul_f32 v95, v216, v94
    v_fma_f32 v79, -v217, v94, v79
    v_fma_f32 v95, v217, v78, v95
    v_mov_b32 v236, 1.0
    v_mov_b32 v237, 0
    v_mov_b32 v238, 1.0
    v_mov_b32 v239, 0
    s_cmp_lt_u32 s4, 0
    s_cbranch_scc1 K1S_SG_DONE
    s_cmp_eq_u32 s4, 0
    s_cselect_b32 exec_lo, 0, -1
    v_mul_f32 v242, v212, v236
    v_mul_f32 v243, v212, v237
    v_fma_f32 v242, -v213, v237, v242
    v_fma_f32 v237, v213, v236, v243
    v_mov_b32 v236, v242
    v_mul_f32 v242, v220, v238
    v_mul_f32 v243, v220, v239
    v_fma_f32 v242, -v221, v239, v242
    v_fma_f32 v239, v221, v238, v243
    v_mov_b32 v238, v242
    s_cmp_le_u32 s4, 0
    s_cbranch_scc1 K1S_SG_DONE
    v_mul_f32 v242, v212, v236
    v_mul_f32 v243, v212, v237
    v_fma_f32 v242, -v213, v237, v242
    v_fma_f32 v237, v213, v236, v243
    v_mov_b32 v236, v242
    v_mul_f32 v242, v220, v238
    v_mul_f32 v243, v220, v239
    v_fma_f32 v242, -v221, v239, v242
    v_fma_f32 v239, v221, v238, v243
    v_mov_b32 v238, v242
    s_cmp_lt_u32 s4, 1
    s_cbranch_scc1 K1S_SG_DONE
    s_cmp_eq_u32 s4, 1
    s_cselect_b32 exec_lo, 0, -1
    v_mul_f32 v242, v212, v236
    v_mul_f32 v243, v212, v237
    v_fma_f32 v242, -v213, v237, v242
    v_fma_f32 v237, v213, v236, v243
    v_mov_b32 v236, v242
    v_mul_f32 v242, v220, v238
    v_mul_f32 v243, v220, v239
    v_fma_f32 v242, -v221, v239, v242
    v_fma_f32 v239, v221, v238, v243
    v_mov_b32 v238, v242
    s_cmp_le_u32 s4, 1
    s_cbranch_scc1 K1S_SG_DONE
    v_mul_f32 v242, v212, v236
    v_mul_f32 v243, v212, v237
    v_fma_f32 v242, -v213, v237, v242
    v_fma_f32 v237, v213, v236, v243
    v_mov_b32 v236, v242
    v_mul_f32 v242, v220, v238
    v_mul_f32 v243, v220, v239
    v_fma_f32 v242, -v221, v239, v242
    v_fma_f32 v239, v221, v238, v243
    v_mov_b32 v238, v242
    s_cmp_lt_u32 s4, 2
    s_cbranch_scc1 K1S_SG_DONE
    s_cmp_eq_u32 s4, 2
    s_cselect_b32 exec_lo, 0, -1
    v_mul_f32 v242, v212, v236
    v_mul_f32 v243, v212, v237
    v_fma_f32 v242, -v213, v237, v242
    v_fma_f32 v237, v213, v236, v243
    v_mov_b32 v236, v242
    v_mul_f32 v242, v220, v238
    v_mul_f32 v243, v220, v239
    v_fma_f32 v242, -v221, v239, v242
    v_fma_f32 v239, v221, v238, v243
    v_mov_b32 v238, v242
    s_cmp_le_u32 s4, 2
    s_cbranch_scc1 K1S_SG_DONE
    v_mul_f32 v242, v212, v236
    v_mul_f32 v243, v212, v237
    v_fma_f32 v242, -v213, v237, v242
    v_fma_f32 v237, v213, v236, v243
    v_mov_b32 v236, v242
    v_mul_f32 v242, v220, v238
    v_mul_f32 v243, v220, v239
    v_fma_f32 v242, -v221, v239, v242
    v_fma_f32 v239, v221, v238, v243
    v_mov_b32 v238, v242
    s_cmp_lt_u32 s4, 3
    s_cbranch_scc1 K1S_SG_DONE
    s_cmp_eq_u32 s4, 3
    s_cselect_b32 exec_lo, 0, -1
    v_mul_f32 v242, v212, v236
    v_mul_f32 v243, v212, v237
    v_fma_f32 v242, -v213, v237, v242
    v_fma_f32 v237, v213, v236, v243
    v_mov_b32 v236, v242
    v_mul_f32 v242, v220, v238
    v_mul_f32 v243, v220, v239
    v_fma_f32 v242, -v221, v239, v242
    v_fma_f32 v239, v221, v238, v243
    v_mov_b32 v238, v242
K1S_SG_DONE:
    s_mov_b64 exec, -1
    s_cmp_eq_u32 s4, 0
    s_cbranch_scc1 K1S_POLLER
    s_branch K1S_NOPOLL
K1S_POLLER:
    v_cmp_lt_u32 vcc, 31, v2
    v_mov_b32 v244, 0
    v_mov_b32 v245, 0
    v_cndmask_b32 v246, v214, v222, vcc
    v_cndmask_b32 v26, v215, v223, vcc
    v_not_b32 v25, v247
    s_cmp_eq_u32 s6, 0
    s_cbranch_scc1 K1S_HDONE
    s_mov_b32 s14, 30000
    s_branch K1S_LOADED
K1S_POLL:
    s_cmp_le_u32 s6, 0
    s_cbranch_scc1 K1S_LOADED
    s_mov_b32 s10, 0
    buffer_load_dwordx4 v[96:99], v24, s[80:83], s10 offen sc1
    s_cmp_le_u32 s6, 1
    s_cbranch_scc1 K1S_LOADED
    s_mov_b32 s10, 10240
    buffer_load_dwordx4 v[100:103], v24, s[80:83], s10 offen sc1
    s_cmp_le_u32 s6, 2
    s_cbranch_scc1 K1S_LOADED
    s_mov_b32 s10, 20480
    buffer_load_dwordx4 v[104:107], v24, s[80:83], s10 offen sc1
    s_cmp_le_u32 s6, 3
    s_cbranch_scc1 K1S_LOADED
    s_mov_b32 s10, 30720
    buffer_load_dwordx4 v[108:111], v24, s[80:83], s10 offen sc1
    s_cmp_le_u32 s6, 4
    s_cbranch_scc1 K1S_LOADED
    s_mov_b32 s10, 40960
    buffer_load_dwordx4 v[112:115], v24, s[80:83], s10 offen sc1
    s_cmp_le_u32 s6, 5
    s_cbranch_scc1 K1S_LOADED
    s_mov_b32 s10, 51200
    buffer_load_dwordx4 v[116:119], v24, s[80:83], s10 offen sc1
    s_cmp_le_u32 s6, 6
    s_cbranch_scc1 K1S_LOADED
    s_mov_b32 s10, 61440
    buffer_load_dwordx4 v[120:123], v24, s[80:83], s10 offen sc1
    s_cmp_le_u32 s6, 7
    s_cbranch_scc1 K1S_LOADED
    s_mov_b32 s10, 71680
    buffer_load_dwordx4 v[124:127], v24, s[80:83], s10 offen sc1
    s_cmp_le_u32 s6, 8
    s_cbranch_scc1 K1S_LOADED
    s_mov_b32 s10, 81920
    buffer_load_dwordx4 v[192:195], v24, s[80:83], s10 offen sc1
    s_cmp_le_u32 s6, 9
    s_cbranch_scc1 K1S_LOADED
    s_mov_b32 s10, 92160
    buffer_load_dwordx4 v[196:199], v24, s[80:83], s10 offen sc1
    s_cmp_le_u32 s6, 10
    s_cbranch_scc1 K1S_LOADED
    s_mov_b32 s10, 102400
    buffer_load_dwordx4 v[200:203], v24, s[80:83], s10 offen sc1
    s_cmp_le_u32 s6, 11
    s_cbranch_scc1 K1S_LOADED
    s_mov_b32 s10, 112640
    buffer_load_dwordx4 v[204:207], v24, s[80:83], s10 offen sc1
    s_cmp_le_u32 s6, 12
    s_cbranch_scc1 K1S_LOADED
    s_mov_b32 s10, 122880
    buffer_load_dwordx4 v[224:227], v24, s[80:83], s10 offen sc1
    s_cmp_le_u32 s6, 13
    s_cbranch_scc1 K1S_LOADED
    s_mov_b32 s10, 133120
    buffer_load_dwordx4 v[228:231], v24, s[80:83], s10 offen sc1
    s_cmp_le_u32 s6, 14
    s_cbranch_scc1 K1S_LOADED
    s_mov_b32 s10, 143360
    buffer_load_dwordx4 v[8:11], v24, s[80:83], s10 offen sc1
K1S_LOADED:
    s_waitcnt vmcnt(0)
    s_mov_b64 s[12:13], -1
    s_cmp_le_u32 s6, 0
    s_cbranch_scc1 K1S_CHK2
    v_cmp_eq_u32 vcc, v98, v247
    v_cmp_eq_u32 s[10:11], v99, v25
    s_and_b64 s[12:13], s[12:13], vcc
    s_and_b64 s[12:13], s[12:13], s[10:11]
    s_cmp_le_u32 s6, 1
    s_cbranch_scc1 K1S_CHK2
    v_cmp_eq_u32 vcc, v102, v247
    v_cmp_eq_u32 s[10:11], v103, v25
    s_and_b64 s[12:13], s[12:13], vcc
    s_and_b64 s[12:13], s[12:13], s[10:11]
    s_cmp_le_u32 s6, 2
    s_cbranch_scc1 K1S_CHK2
    v_cmp_eq_u32 vcc, v106, v247
    v_cmp_eq_u32 s[10:11], v107, v25
    s_and_b64 s[12:13], s[12:13], vcc
    s_and_b64 s[12:13], s[12:13], s[10:11]
    s_cmp_le_u32 s6, 3
    s_cbranch_scc1 K1S_CHK2
    v_cmp_eq_u32 vcc, v110, v247
    v_cmp_eq_u32 s[10:11], v111, v25
    s_and_b64 s[12:13], s[12:13], vcc
    s_and_b64 s[12:13], s[12:13], s[10:11]
    s_cmp_le_u32 s6, 4
    s_cbranch_scc1 K1S_CHK2
    v_cmp_eq_u32 vcc, v114, v247
    v_cmp_eq_u32 s[10:11], v115, v25
    s_and_b64 s[12:13], s[12:13], vcc
    s_and_b64 s[12:13], s[12:13], s[10:11]
    s_cmp_le_u32 s6, 5
    s_cbranch_scc1 K1S_CHK2
    v_cmp_eq_u32 vcc, v118, v247
    v_cmp_eq_u32 s[10:11], v119, v25
    s_and_b64 s[12:13], s[12:13], vcc
    s_and_b64 s[12:13], s[12:13], s[10:11]
    s_cmp_le_u32 s6, 6
    s_cbranch_scc1 K1S_CHK2
    v_cmp_eq_u32 vcc, v122, v247
    v_cmp_eq_u32 s[10:11], v123, v25
    s_and_b64 s[12:13], s[12:13], vcc
    s_and_b64 s[12:13], s[12:13], s[10:11]
    s_cmp_le_u32 s6, 7
    s_cbranch_scc1 K1S_CHK2
    v_cmp_eq_u32 vcc, v126, v247
    v_cmp_eq_u32 s[10:11], v127, v25
    s_and_b64 s[12:13], s[12:13], vcc
    s_and_b64 s[12:13], s[12:13], s[10:11]
    s_cmp_le_u32 s6, 8
    s_cbranch_scc1 K1S_CHK2
    v_cmp_eq_u32 vcc, v194, v247
    v_cmp_eq_u32 s[10:11], v195, v25
    s_and_b64 s[12:13], s[12:13], vcc
    s_and_b64 s[12:13], s[12:13], s[10:11]
    s_cmp_le_u32 s6, 9
    s_cbranch_scc1 K1S_CHK2
    v_cmp_eq_u32 vcc, v198, v247
    v_cmp_eq_u32 s[10:11], v199, v25
    s_and_b64 s[12:13], s[12:13], vcc
    s_and_b64 s[12:13], s[12:13], s[10:11]
    s_cmp_le_u32 s6, 10
    s_cbranch_scc1 K1S_CHK2
    v_cmp_eq_u32 vcc, v202, v247
    v_cmp_eq_u32 s[10:11], v203, v25
    s_and_b64 s[12:13], s[12:13], vcc
    s_and_b64 s[12:13], s[12:13], s[10:11]
    s_cmp_le_u32 s6, 11
    s_cbranch_scc1 K1S_CHK2
    v_cmp_eq_u32 vcc, v206, v247
    v_cmp_eq_u32 s[10:11], v207, v25
    s_and_b64 s[12:13], s[12:13], vcc
    s_and_b64 s[12:13], s[12:13], s[10:11]
    s_cmp_le_u32 s6, 12
    s_cbranch_scc1 K1S_CHK2
    v_cmp_eq_u32 vcc, v226, v247
    v_cmp_eq_u32 s[10:11], v227, v25
    s_and_b64 s[12:13], s[12:13], vcc
    s_and_b64 s[12:13], s[12:13], s[10:11]
    s_cmp_le_u32 s6, 13
    s_cbranch_scc1 K1S_CHK2
    v_cmp_eq_u32 vcc, v230, v247
    v_cmp_eq_u32 s[10:11], v231, v25
    s_and_b64 s[12:13], s[12:13], vcc
    s_and_b64 s[12:13], s[12:13], s[10:11]
    s_cmp_le_u32 s6, 14
    s_cbranch_scc1 K1S_CHK2
    v_cmp_eq_u32 vcc, v10, v247
    v_cmp_eq_u32 s[10:11], v11, v25
    s_and_b64 s[12:13], s[12:13], vcc
    s_and_b64 s[12:13], s[12:13], s[10:11]
K1S_CHK2:
    s_cmp_eq_u64 s[12:13], -1
    s_cbranch_scc1 K1S_VALID
    s_sub_u32 s14, s14, 1
    s_cmp_eq_u32 s14, 0
    s_cbranch_scc1 K1S_VALID
    s_branch K1S_POLL
K1S_VALID:
    s_cmp_le_u32 s6, 0
    s_cbranch_scc1 K1S_HDONE
    v_fma_f32 v240, v246, v244, v96
    v_fma_f32 v241, v246, v245, v97
    v_fma_f32 v240, -v26, v245, v240
    v_fma_f32 v245, v26, v244, v241
    v_mov_b32 v244, v240
    s_cmp_le_u32 s6, 1
    s_cbranch_scc1 K1S_HDONE
    v_fma_f32 v240, v246, v244, v100
    v_fma_f32 v241, v246, v245, v101
    v_fma_f32 v240, -v26, v245, v240
    v_fma_f32 v245, v26, v244, v241
    v_mov_b32 v244, v240
    s_cmp_le_u32 s6, 2
    s_cbranch_scc1 K1S_HDONE
    v_fma_f32 v240, v246, v244, v104
    v_fma_f32 v241, v246, v245, v105
    v_fma_f32 v240, -v26, v245, v240
    v_fma_f32 v245, v26, v244, v241
    v_mov_b32 v244, v240
    s_cmp_le_u32 s6, 3
    s_cbranch_scc1 K1S_HDONE
    v_fma_f32 v240, v246, v244, v108
    v_fma_f32 v241, v246, v245, v109
    v_fma_f32 v240, -v26, v245, v240
    v_fma_f32 v245, v26, v244, v241
    v_mov_b32 v244, v240
    s_cmp_le_u32 s6, 4
    s_cbranch_scc1 K1S_HDONE
    v_fma_f32 v240, v246, v244, v112
    v_fma_f32 v241, v246, v245, v113
    v_fma_f32 v240, -v26, v245, v240
    v_fma_f32 v245, v26, v244, v241
    v_mov_b32 v244, v240
    s_cmp_le_u32 s6, 5
    s_cbranch_scc1 K1S_HDONE
    v_fma_f32 v240, v246, v244, v116
    v_fma_f32 v241, v246, v245, v117
    v_fma_f32 v240, -v26, v245, v240
    v_fma_f32 v245, v26, v244, v241
    v_mov_b32 v244, v240
    s_cmp_le_u32 s6, 6
    s_cbranch_scc1 K1S_HDONE
    v_fma_f32 v240, v246, v244, v120
    v_fma_f32 v241, v246, v245, v121
    v_fma_f32 v240, -v26, v245, v240
    v_fma_f32 v245, v26, v244, v241
    v_mov_b32 v244, v240
    s_cmp_le_u32 s6, 7
    s_cbranch_scc1 K1S_HDONE
    v_fma_f32 v240, v246, v244, v124
    v_fma_f32 v241, v246, v245, v125
    v_fma_f32 v240, -v26, v245, v240
    v_fma_f32 v245, v26, v244, v241
    v_mov_b32 v244, v240
    s_cmp_le_u32 s6, 8
    s_cbranch_scc1 K1S_HDONE
    v_fma_f32 v240, v246, v244, v192
    v_fma_f32 v241, v246, v245, v193
    v_fma_f32 v240, -v26, v245, v240
    v_fma_f32 v245, v26, v244, v241
    v_mov_b32 v244, v240
    s_cmp_le_u32 s6, 9
    s_cbranch_scc1 K1S_HDONE
    v_fma_f32 v240, v246, v244, v196
    v_fma_f32 v241, v246, v245, v197
    v_fma_f32 v240, -v26, v245, v240
    v_fma_f32 v245, v26, v244, v241
    v_mov_b32 v244, v240
    s_cmp_le_u32 s6, 10
    s_cbranch_scc1 K1S_HDONE
    v_fma_f32 v240, v246, v244, v200
    v_fma_f32 v241, v246, v245, v201
    v_fma_f32 v240, -v26, v245, v240
    v_fma_f32 v245, v26, v244, v241
    v_mov_b32 v244, v240
    s_cmp_le_u32 s6, 11
    s_cbranch_scc1 K1S_HDONE
    v_fma_f32 v240, v246, v244, v204
    v_fma_f32 v241, v246, v245, v205
    v_fma_f32 v240, -v26, v245, v240
    v_fma_f32 v245, v26, v244, v241
    v_mov_b32 v244, v240
    s_cmp_le_u32 s6, 12
    s_cbranch_scc1 K1S_HDONE
    v_fma_f32 v240, v246, v244, v224
    v_fma_f32 v241, v246, v245, v225
    v_fma_f32 v240, -v26, v245, v240
    v_fma_f32 v245, v26, v244, v241
    v_mov_b32 v244, v240
    s_cmp_le_u32 s6, 13
    s_cbranch_scc1 K1S_HDONE
    v_fma_f32 v240, v246, v244, v228
    v_fma_f32 v241, v246, v245, v229
    v_fma_f32 v240, -v26, v245, v240
    v_fma_f32 v245, v26, v244, v241
    v_mov_b32 v244, v240
    s_cmp_le_u32 s6, 14
    s_cbranch_scc1 K1S_HDONE
    v_fma_f32 v240, v246, v244, v8
    v_fma_f32 v241, v246, v245, v9
    v_fma_f32 v240, -v26, v245, v240
    v_fma_f32 v245, v26, v244, v241
    v_mov_b32 v244, v240
K1S_HDONE:
    s_lshl_b32 s10, s5, 6
    v_add_u32 v3, s10, v2
    v_lshlrev_b32 v3, 3, v3
    ds_write_b64 v3, v[244:245] offset:16384
    s_waitcnt lgkmcnt(0)
K1S_NOPOLL:
    s_waitcnt vmcnt(0)
    v_readfirstlane_b32 s70, v1
    s_barrier
    ds_read_b64 v[240:241], v22 offset:16384
    ds_read_b64 v[242:243], v22 offset:16640
    s_waitcnt lgkmcnt(0)
    v_fma_f32 v232, v236, v240, v232
    v_fma_f32 v233, v236, v241, v233
    v_fma_f32 v232, -v237, v241, v232
    v_fma_f32 v233, v237, v240, v233
    v_fma_f32 v234, v238, v242, v234
    v_fma_f32 v235, v238, v243, v235
    v_fma_f32 v234, -v239, v243, v234
    v_fma_f32 v235, v239, v242, v235
    v_pk_fma_f32 v[128:129], v[32:33], v[232:233], v[128:129] op_sel_hi:[1,0,1]
    v_pk_fma_f32 v[144:145], v[32:33], v[232:233], v[144:145] op_sel:[0,1,0]
    v_pk_fma_f32 v[128:129], v[48:49], v[232:233], v[128:129] op_sel:[0,1,0] neg_lo:[0,1,0] neg_hi:[0,1,0]
    v_pk_fma_f32 v[144:145], v[48:49], v[232:233], v[144:145] op_sel_hi:[1,0,1]
    v_pk_fma_f32 v[130:131], v[34:35], v[232:233], v[130:131] op_sel_hi:[1,0,1]
    v_pk_fma_f32 v[146:147], v[34:35], v[232:233], v[146:147] op_sel:[0,1,0]
    v_pk_fma_f32 v[130:131], v[50:51], v[232:233], v[130:131] op_sel:[0,1,0] neg_lo:[0,1,0] neg_hi:[0,1,0]
    v_pk_fma_f32 v[146:147], v[50:51], v[232:233], v[146:147] op_sel_hi:[1,0,1]
    v_pk_fma_f32 v[132:133], v[36:37], v[232:233], v[132:133] op_sel_hi:[1,0,1]
    v_pk_fma_f32 v[148:149], v[36:37], v[232:233], v[148:149] op_sel:[0,1,0]
    v_pk_fma_f32 v[132:133], v[52:53], v[232:233], v[132:133] op_sel:[0,1,0] neg_lo:[0,1,0] neg_hi:[0,1,0]
    v_pk_fma_f32 v[148:149], v[52:53], v[232:233], v[148:149] op_sel_hi:[1,0,1]
    v_pk_fma_f32 v[134:135], v[38:39], v[232:233], v[134:135] op_sel_hi:[1,0,1]
    v_pk_fma_f32 v[150:151], v[38:39], v[232:233], v[150:151] op_sel:[0,1,0]
    v_pk_fma_f32 v[134:135], v[54:55], v[232:233], v[134:135] op_sel:[0,1,0] neg_lo:[0,1,0] neg_hi:[0,1,0]
    v_pk_fma_f32 v[150:151], v[54:55], v[232:233], v[150:151] op_sel_hi:[1,0,1]
    v_pk_fma_f32 v[136:137], v[40:41], v[232:233], v[136:137] op_sel_hi:[1,0,1]
    v_pk_fma_f32 v[152:153], v[40:41], v[232:233], v[152:153] op_sel:[0,1,0]
    v_pk_fma_f32 v[136:137], v[56:57], v[232:233], v[136:137] op_sel:[0,1,0] neg_lo:[0,1,0] neg_hi:[0,1,0]
    v_pk_fma_f32 v[152:153], v[56:57], v[232:233], v[152:153] op_sel_hi:[1,0,1]
    v_pk_fma_f32 v[138:139], v[42:43], v[232:233], v[138:139] op_sel_hi:[1,0,1]
    v_pk_fma_f32 v[154:155], v[42:43], v[232:233], v[154:155] op_sel:[0,1,0]
    v_pk_fma_f32 v[138:139], v[58:59], v[232:233], v[138:139] op_sel:[0,1,0] neg_lo:[0,1,0] neg_hi:[0,1,0]
    v_pk_fma_f32 v[154:155], v[58:59], v[232:233], v[154:155] op_sel_hi:[1,0,1]
    v_pk_fma_f32 v[140:141], v[44:45], v[232:233], v[140:141] op_sel_hi:[1,0,1]
    v_pk_fma_f32 v[156:157], v[44:45], v[232:233], v[156:157] op_sel:[0,1,0]
    v_pk_fma_f32 v[140:141], v[60:61], v[232:233], v[140:141] op_sel:[0,1,0] neg_lo:[0,1,0] neg_hi:[0,1,0]
    v_pk_fma_f32 v[156:157], v[60:61], v[232:233], v[156:157] op_sel_hi:[1,0,1]
    v_pk_fma_f32 v[142:143], v[46:47], v[232:233], v[142:143] op_sel_hi:[1,0,1]
    v_pk_fma_f32 v[158:159], v[46:47], v[232:233], v[158:159] op_sel:[0,1,0]
    v_pk_fma_f32 v[142:143], v[62:63], v[232:233], v[142:143] op_sel:[0,1,0] neg_lo:[0,1,0] neg_hi:[0,1,0]
    v_pk_fma_f32 v[158:159], v[62:63], v[232:233], v[158:159] op_sel_hi:[1,0,1]
    v_pk_fma_f32 v[160:161], v[64:65], v[234:235], v[160:161] op_sel_hi:[1,0,1]
    v_pk_fma_f32 v[176:177], v[64:65], v[234:235], v[176:177] op_sel:[0,1,0]
    v_pk_fma_f32 v[160:161], v[80:81], v[234:235], v[160:161] op_sel:[0,1,0] neg_lo:[0,1,0] neg_hi:[0,1,0]
    v_pk_fma_f32 v[176:177], v[80:81], v[234:235], v[176:177] op_sel_hi:[1,0,1]
    v_pk_fma_f32 v[162:163], v[66:67], v[234:235], v[162:163] op_sel_hi:[1,0,1]
    v_pk_fma_f32 v[178:179], v[66:67], v[234:235], v[178:179] op_sel:[0,1,0]
    v_pk_fma_f32 v[162:163], v[82:83], v[234:235], v[162:163] op_sel:[0,1,0] neg_lo:[0,1,0] neg_hi:[0,1,0]
    v_pk_fma_f32 v[178:179], v[82:83], v[234:235], v[178:179] op_sel_hi:[1,0,1]
    v_pk_fma_f32 v[164:165], v[68:69], v[234:235], v[164:165] op_sel_hi:[1,0,1]
    v_pk_fma_f32 v[180:181], v[68:69], v[234:235], v[180:181] op_sel:[0,1,0]
    v_pk_fma_f32 v[164:165], v[84:85], v[234:235], v[164:165] op_sel:[0,1,0] neg_lo:[0,1,0] neg_hi:[0,1,0]
    v_pk_fma_f32 v[180:181], v[84:85], v[234:235], v[180:181] op_sel_hi:[1,0,1]
    v_pk_fma_f32 v[166:167], v[70:71], v[234:235], v[166:167] op_sel_hi:[1,0,1]
    v_pk_fma_f32 v[182:183], v[70:71], v[234:235], v[182:183] op_sel:[0,1,0]
    v_pk_fma_f32 v[166:167], v[86:87], v[234:235], v[166:167] op_sel:[0,1,0] neg_lo:[0,1,0] neg_hi:[0,1,0]
    v_pk_fma_f32 v[182:183], v[86:87], v[234:235], v[182:183] op_sel_hi:[1,0,1]
    v_pk_fma_f32 v[168:169], v[72:73], v[234:235], v[168:169] op_sel_hi:[1,0,1]
    v_pk_fma_f32 v[184:185], v[72:73], v[234:235], v[184:185] op_sel:[0,1,0]
    v_pk_fma_f32 v[168:169], v[88:89], v[234:235], v[168:169] op_sel:[0,1,0] neg_lo:[0,1,0] neg_hi:[0,1,0]
    v_pk_fma_f32 v[184:185], v[88:89], v[234:235], v[184:185] op_sel_hi:[1,0,1]
    v_pk_fma_f32 v[170:171], v[74:75], v[234:235], v[170:171] op_sel_hi:[1,0,1]
    v_pk_fma_f32 v[186:187], v[74:75], v[234:235], v[186:187] op_sel:[0,1,0]
    v_pk_fma_f32 v[170:171], v[90:91], v[234:235], v[170:171] op_sel:[0,1,0] neg_lo:[0,1,0] neg_hi:[0,1,0]
    v_pk_fma_f32 v[186:187], v[90:91], v[234:235], v[186:187] op_sel_hi:[1,0,1]
    v_pk_fma_f32 v[172:173], v[76:77], v[234:235], v[172:173] op_sel_hi:[1,0,1]
    v_pk_fma_f32 v[188:189], v[76:77], v[234:235], v[188:189] op_sel:[0,1,0]
    v_pk_fma_f32 v[172:173], v[92:93], v[234:235], v[172:173] op_sel:[0,1,0] neg_lo:[0,1,0] neg_hi:[0,1,0]
    v_pk_fma_f32 v[188:189], v[92:93], v[234:235], v[188:189] op_sel_hi:[1,0,1]
    v_pk_fma_f32 v[174:175], v[78:79], v[234:235], v[174:175] op_sel_hi:[1,0,1]
    v_pk_fma_f32 v[190:191], v[78:79], v[234:235], v[190:191] op_sel:[0,1,0]
    v_pk_fma_f32 v[174:175], v[94:95], v[234:235], v[174:175] op_sel:[0,1,0] neg_lo:[0,1,0] neg_hi:[0,1,0]
    v_pk_fma_f32 v[190:191], v[94:95], v[234:235], v[190:191] op_sel_hi:[1,0,1]
    s_mul_i32 s10, s3, 10240
    s_add_u32 s10, s10, 20480
    v_and_b32 v3, 31, v2
    v_mul_u32_u24 v3, 80, v3
    v_lshrrev_b32 v4, 5, v2
    v_lshl_add_u32 v3, v4, 5, v3
    v_add_u32 v28, s10, v3
    v_cvt_pk_bf16_f32 v32, v128, v129
    v_cvt_pk_bf16_f32 v33, v130, v131
    v_cvt_pk_bf16_f32 v34, v132, v133
    v_cvt_pk_bf16_f32 v35, v134, v135
    v_cvt_pk_bf16_f32 v36, v136, v137
    v_cvt_pk_bf16_f32 v37, v138, v139
    v_cvt_pk_bf16_f32 v38, v140, v141
    v_cvt_pk_bf16_f32 v39, v142, v143
    ds_write_b128 v28, v[32:35] offset:0
    ds_write_b128 v28, v[36:39] offset:16
    v_cvt_pk_bf16_f32 v40, -v144, -v145
    v_cvt_pk_bf16_f32 v41, -v146, -v147
    v_cvt_pk_bf16_f32 v42, -v148, -v149
    v_cvt_pk_bf16_f32 v43, -v150, -v151
    v_cvt_pk_bf16_f32 v44, -v152, -v153
    v_cvt_pk_bf16_f32 v45, -v154, -v155
    v_cvt_pk_bf16_f32 v46, -v156, -v157
    v_cvt_pk_bf16_f32 v47, -v158, -v159
    ds_write_b128 v28, v[40:43] offset:2560
    ds_write_b128 v28, v[44:47] offset:2576
    v_cvt_pk_bf16_f32 v48, v160, v161
    v_cvt_pk_bf16_f32 v49, v162, v163
    v_cvt_pk_bf16_f32 v50, v164, v165
    v_cvt_pk_bf16_f32 v51, v166, v167
    v_cvt_pk_bf16_f32 v52, v168, v169
    v_cvt_pk_bf16_f32 v53, v170, v171
    v_cvt_pk_bf16_f32 v54, v172, v173
    v_cvt_pk_bf16_f32 v55, v174, v175
    ds_write_b128 v28, v[48:51] offset:5120
    ds_write_b128 v28, v[52:55] offset:5136
    v_cvt_pk_bf16_f32 v56, -v176, -v177
    v_cvt_pk_bf16_f32 v57, -v178, -v179
    v_cvt_pk_bf16_f32 v58, -v180, -v181
    v_cvt_pk_bf16_f32 v59, -v182, -v183
    v_cvt_pk_bf16_f32 v60, -v184, -v185
    v_cvt_pk_bf16_f32 v61, -v186, -v187
    v_cvt_pk_bf16_f32 v62, -v188, -v189
    v_cvt_pk_bf16_f32 v63, -v190, -v191
    ds_write_b128 v28, v[56:59] offset:7680
    ds_write_b128 v28, v[60:63] offset:7696
    v_lshrrev_b32 v3, 4, v2
    v_lshlrev_b32 v3, 3, v3
    v_bfe_u32 v4, v2, 2, 2
    v_add_u32 v3, v3, v4
    v_mul_u32_u24 v3, 80, v3
    v_and_b32 v4, 3, v2
    v_lshl_add_u32 v3, v4, 3, v3
    v_add_u32 v29, s10, v3
    v_lshlrev_b32 v30, 4, v2
    s_lshl_b32 s10, s6, 1
    s_lshr_b32 s11, s4, 1
    s_add_u32 s10, s10, s11
    s_mul_i32 s10, s10, 94
    s_lshr_b32 s11, s68, 4
    s_add_u32 s10, s10, s11
    s_lshl_b32 s10, s10, 12
    s_and_b32 s11, s4, 1
    s_lshl_b32 s11, s11, 11
    s_add_u32 s10, s10, s11
    s_waitcnt lgkmcnt(0)
    ds_read_b64_tr_b16 v[64:65], v29 offset:0
    ds_read_b64_tr_b16 v[66:67], v29 offset:320
    ds_read_b64_tr_b16 v[68:69], v29 offset:32
    ds_read_b64_tr_b16 v[70:71], v29 offset:352
    ds_read_b64_tr_b16 v[72:73], v29 offset:2560
    ds_read_b64_tr_b16 v[74:75], v29 offset:2880
    ds_read_b64_tr_b16 v[76:77], v29 offset:2592
    ds_read_b64_tr_b16 v[78:79], v29 offset:2912
    ds_read_b64_tr_b16 v[80:81], v29 offset:5120
    ds_read_b64_tr_b16 v[82:83], v29 offset:5440
    ds_read_b64_tr_b16 v[84:85], v29 offset:5152
    ds_read_b64_tr_b16 v[86:87], v29 offset:5472
    ds_read_b64_tr_b16 v[88:89], v29 offset:7680
    ds_read_b64_tr_b16 v[90:91], v29 offset:8000
    ds_read_b64_tr_b16 v[92:93], v29 offset:7712
    ds_read_b64_tr_b16 v[94:95], v29 offset:8032
    s_waitcnt lgkmcnt(0)
    s_add_u32 s11, s10, 0
    buffer_store_dwordx4 v[64:67], v30, s[64:67], s11 offen sc1
    s_add_u32 s11, s10, 1024
    buffer_store_dwordx4 v[68:71], v30, s[64:67], s11 offen sc1
    s_add_u32 s11, s10, 4096
    buffer_store_dwordx4 v[72:75], v30, s[64:67], s11 offen sc1
    s_add_u32 s11, s10, 5120
    buffer_store_dwordx4 v[76:79], v30, s[64:67], s11 offen sc1
    s_add_u32 s11, s10, 8192
    buffer_store_dwordx4 v[80:83], v30, s[64:67], s11 offen sc1
    s_add_u32 s11, s10, 9216
    buffer_store_dwordx4 v[84:87], v30, s[64:67], s11 offen sc1
    s_add_u32 s11, s10, 12288
    buffer_store_dwordx4 v[88:91], v30, s[64:67], s11 offen sc1
    s_add_u32 s11, s10, 13312
    buffer_store_dwordx4 v[92:95], v30, s[64:67], s11 offen sc1
    s_lshl_b32 s10, s6, 7
    s_lshl_b32 s11, s7, 2
    s_add_u32 s10, s10, s11
    s_add_u32 s10, s10, 32514048
    s_mov_b32 s71, s10
PHASE2:
    s_and_b32 s4, s2, 7
    s_lshr_b32 s5, s2, 3
    s_lshr_b32 s6, s4, 1
    s_lshl_b32 s6, s6, 3
    s_and_b32 s7, s5, 7
    s_add_u32 s6, s6, s7
    s_and_b32 s7, s4, 1
    s_lshl_b32 s7, s7, 2
    s_lshr_b32 s8, s5, 3
    s_add_u32 s7, s7, s8
    s_sub_u32 s9, s3, 4
    s_mul_i32 s8, s9, 10
    s_mov_b32 s12, 10
    s_cmp_ge_u32 s3, 4
    s_cbranch_scc1 K2_RNG
    s_mul_i32 s8, s3, 14
    s_add_u32 s8, s8, 40
    s_mov_b32 s12, 14
    s_cmp_lt_u32 s3, 2
    s_cbranch_scc1 K2_RNG
    s_mul_i32 s8, s3, 13
    s_add_u32 s8, s8, 42
    s_mov_b32 s12, 13
K2_RNG:
    v_lshlrev_b32 v3, 4, v2
    v_add_u32 v4, 4096, v3
    v_readfirstlane_b32 s73, v247
    s_add_u32 s48, s46, 4194304
    s_addc_u32 s49, s47, 0
    s_mov_b32 s50, 12320768
    s_mov_b32 s51, 0x20000
    s_add_u32 s52, s46, 20971520
    s_addc_u32 s53, s47, 0
    s_mov_b32 s54, 3850240
    s_mov_b32 s55, 0x20000
    s_mul_i32 s10, s6, 94
    s_add_u32 s10, s10, s8
    s_lshl_b32 s10, s10, 12
    s_mul_i32 s11, s7, 94
    s_add_u32 s11, s11, s8
    s_mul_i32 s11, s11, 5120
    s_cmp_eq_u32 s70, s73
    s_cbranch_scc1 P2_PDB
    s_lshl_b32 s15, s5, 7
    s_add_u32 s15, s15, 32505856
    v_lshlrev_b32 v5, 2, v2
    v_add_u32 v5, s15, v5
    s_mov_b32 s14, 30000
P2_POLLB:
    s_mov_b64 exec, 0x1
    global_load_dword v8, v5, s[46:47] sc1
    s_waitcnt vmcnt(0)
    v_cmp_ne_u32 vcc, s73, v8
    s_mov_b64 exec, -1
    s_sub_u32 s14, s14, 1
    s_cmp_eq_u32 s14, 0
    s_cbranch_scc1 P2_PDB
    s_cmp_eq_u64 vcc, 0
    s_cbranch_scc1 P2_PDB
    s_sleep 2
    s_branch P2_POLLB
P2_PDB:
    v_add_u32 v10, 0, v3
    v_add_u32 v11, 1024, v3
    v_add_u32 v12, 2048, v3
    v_add_u32 v13, 3072, v3
    s_barrier
    buffer_load_dwordx4 v[48:51], v3, s[52:55], s11 offen offset:0 sc1
    buffer_load_dwordx4 v[52:55], v3, s[52:55], s11 offen offset:1024 sc1
    buffer_load_dwordx4 v[56:59], v3, s[52:55], s11 offen offset:2048 sc1
    buffer_load_dwordx4 v[60:63], v3, s[52:55], s11 offen offset:3072 sc1
    buffer_load_dwordx4 v[64:67], v4, s[52:55], s11 offen sc1
    s_add_u32 s11, s11, 5120
    buffer_load_dwordx4 v[84:87], v3, s[52:55], s11 offen offset:0 sc1
    buffer_load_dwordx4 v[88:91], v3, s[52:55], s11 offen offset:1024 sc1
    buffer_load_dwordx4 v[92:95], v3, s[52:55], s11 offen offset:2048 sc1
    buffer_load_dwordx4 v[96:99], v3, s[52:55], s11 offen offset:3072 sc1
    buffer_load_dwordx4 v[100:103], v4, s[52:55], s11 offen sc1
    s_add_u32 s11, s11, 5120
    buffer_load_dwordx4 v[120:123], v3, s[52:55], s11 offen offset:0 sc1
    buffer_load_dwordx4 v[124:127], v3, s[52:55], s11 offen offset:1024 sc1
    buffer_load_dwordx4 v[128:131], v3, s[52:55], s11 offen offset:2048 sc1
    buffer_load_dwordx4 v[132:135], v3, s[52:55], s11 offen offset:3072 sc1
    buffer_load_dwordx4 v[136:139], v4, s[52:55], s11 offen sc1
    s_add_u32 s11, s11, 5120
    s_waitcnt vmcnt(15)
    s_barrier
    s_cmp_eq_u32 s3, 0
    s_cbranch_scc0 P2_ARR
    v_mov_b32 v27, s71
    s_mov_b64 exec, 1
    global_store_dword v27, v247, s[46:47] sc1
    s_mov_b64 exec, -1
P2_ARR:
    s_mul_i32 s14, s3, 20480
    s_add_u32 m0, s14, 0
    s_nop 0
    buffer_load_dwordx4 v10, s[52:55], s11 offen sc1 lds
    s_add_u32 m0, s14, 1024
    s_nop 0
    buffer_load_dwordx4 v11, s[52:55], s11 offen sc1 lds
    s_add_u32 m0, s14, 2048
    s_nop 0
    buffer_load_dwordx4 v12, s[52:55], s11 offen sc1 lds
    s_add_u32 m0, s14, 3072
    s_nop 0
    buffer_load_dwordx4 v13, s[52:55], s11 offen sc1 lds
    s_add_u32 m0, s14, 4096
    s_nop 0
    buffer_load_dwordx4 v4, s[52:55], s11 offen sc1 lds
    s_add_u32 s11, s11, 5120
    s_add_u32 m0, s14, 5120
    s_nop 0
    buffer_load_dwordx4 v10, s[52:55], s11 offen sc1 lds
    s_add_u32 m0, s14, 6144
    s_nop 0
    buffer_load_dwordx4 v11, s[52:55], s11 offen sc1 lds
    s_add_u32 m0, s14, 7168
    s_nop 0
    buffer_load_dwordx4 v12, s[52:55], s11 offen sc1 lds
    s_add_u32 m0, s14, 8192
    s_nop 0
    buffer_load_dwordx4 v13, s[52:55], s11 offen sc1 lds
    s_add_u32 m0, s14, 9216
    s_nop 0
    buffer_load_dwordx4 v4, s[52:55], s11 offen sc1 lds
    s_add_u32 s11, s11, 5120
    s_add_u32 m0, s14, 10240
    s_nop 0
    buffer_load_dwordx4 v10, s[52:55], s11 offen sc1 lds
    s_add_u32 m0, s14, 11264
    s_nop 0
    buffer_load_dwordx4 v11, s[52:55], s11 offen sc1 lds
    s_add_u32 m0, s14, 12288
    s_nop 0
    buffer_load_dwordx4 v12, s[52:55], s11 offen sc1 lds
    s_add_u32 m0, s14, 13312
    s_nop 0
    buffer_load_dwordx4 v13, s[52:55], s11 offen sc1 lds
    s_add_u32 m0, s14, 14336
    s_nop 0
    buffer_load_dwordx4 v4, s[52:55], s11 offen sc1 lds
    s_add_u32 s11, s11, 5120
    s_add_u32 m0, s14, 15360
    s_nop 0
    buffer_load_dwordx4 v10, s[52:55], s11 offen sc1 lds
    s_add_u32 m0, s14, 16384
    s_nop 0
    buffer_load_dwordx4 v11, s[52:55], s11 offen sc1 lds
    s_add_u32 m0, s14, 17408
    s_nop 0
    buffer_load_dwordx4 v12, s[52:55], s11 offen sc1 lds
    s_add_u32 m0, s14, 18432
    s_nop 0
    buffer_load_dwordx4 v13, s[52:55], s11 offen sc1 lds
    s_add_u32 m0, s14, 19456
    s_nop 0
    buffer_load_dwordx4 v4, s[52:55], s11 offen sc1 lds
    s_add_u32 s11, s11, 5120
    s_cmp_eq_u32 s3, 0
    s_cbranch_scc0 P2_W1
    s_lshr_b32 s15, s6, 1
    s_lshl_b32 s15, s15, 7
    s_add_u32 s15, s15, 32509952
    v_lshlrev_b32 v5, 2, v2
    v_add_u32 v5, s15, v5
    s_mov_b32 s14, 30000
P2_POLLF:
    s_mov_b64 exec, 0x7ff
    global_load_dword v8, v5, s[46:47] sc1
    s_waitcnt vmcnt(0)
    v_cmp_ne_u32 vcc, s73, v8
    s_mov_b64 exec, -1
    s_sub_u32 s14, s14, 1
    s_cmp_eq_u32 s14, 0
    s_cbranch_scc1 P2_PDF
    s_cmp_eq_u64 vcc, 0
    s_cbranch_scc1 P2_PDF
    s_branch P2_POLLF
P2_PDF:
P2_W1:
    s_barrier
    s_cmp_lt_u32 s3, 4
    s_cbranch_scc1 P2_W2
    s_lshr_b32 s15, s6, 1
    s_lshl_b32 s15, s15, 7
    s_add_u32 s15, s15, 32514048
    v_lshlrev_b32 v5, 2, v2
    v_add_u32 v5, s15, v5
    s_mov_b32 s14, 30000
P2_POLLS:
    s_mov_b64 exec, 0x1f
    global_load_dword v8, v5, s[46:47] sc1
    s_waitcnt vmcnt(0)
    v_cmp_ne_u32 vcc, s73, v8
    s_mov_b64 exec, -1
    s_sub_u32 s14, s14, 1
    s_cmp_eq_u32 s14, 0
    s_cbranch_scc1 P2_PDS
    s_cmp_eq_u64 vcc, 0
    s_cbranch_scc1 P2_PDS
    s_sleep 1
    s_branch P2_POLLS
P2_PDS:
P2_W2:
    buffer_load_dwordx4 v[32:35], v3, s[48:51], s10 offen offset:0 sc1
    buffer_load_dwordx4 v[36:39], v3, s[48:51], s10 offen offset:1024 sc1
    buffer_load_dwordx4 v[40:43], v3, s[48:51], s10 offen offset:2048 sc1
    buffer_load_dwordx4 v[44:47], v3, s[48:51], s10 offen offset:3072 sc1
    s_add_u32 s10, s10, 4096
    buffer_load_dwordx4 v[68:71], v3, s[48:51], s10 offen offset:0 sc1
    buffer_load_dwordx4 v[72:75], v3, s[48:51], s10 offen offset:1024 sc1
    buffer_load_dwordx4 v[76:79], v3, s[48:51], s10 offen offset:2048 sc1
    buffer_load_dwordx4 v[80:83], v3, s[48:51], s10 offen offset:3072 sc1
    s_add_u32 s10, s10, 4096
    buffer_load_dwordx4 v[104:107], v3, s[48:51], s10 offen offset:0 sc1
    buffer_load_dwordx4 v[108:111], v3, s[48:51], s10 offen offset:1024 sc1
    buffer_load_dwordx4 v[112:115], v3, s[48:51], s10 offen offset:2048 sc1
    buffer_load_dwordx4 v[116:119], v3, s[48:51], s10 offen offset:3072 sc1
    s_add_u32 s10, s10, 4096
    s_mov_b32 s56, s16
    s_mov_b32 s57, s17
    s_mov_b32 s58, 2621440
    s_mov_b32 s59, 0x20000
    s_add_u32 s60, s46, 30408704
    s_addc_u32 s61, s47, 0
    s_mov_b32 s62, 32768
    s_mov_b32 s63, 0x20000
    s_mov_b32 s64, s32
    s_mov_b32 s65, s33
    s_mov_b32 s66, 1280
    s_mov_b32 s67, 0x20000
    s_mov_b32 s68, s42
    s_mov_b32 s69, s43
    s_mov_b32 s70, 5242880
    s_mov_b32 s71, 0x20000
    v_mov_b32 v176, 0
    v_mov_b32 v177, 0
    v_mov_b32 v178, 0
    v_mov_b32 v179, 0
    v_mov_b32 v180, 0
    v_mov_b32 v181, 0
    v_mov_b32 v182, 0
    v_mov_b32 v183, 0
    v_mov_b32 v184, 0
    v_mov_b32 v185, 0
    v_mov_b32 v186, 0
    v_mov_b32 v187, 0
    v_mov_b32 v188, 0
    v_mov_b32 v189, 0
    v_mov_b32 v190, 0
    v_mov_b32 v191, 0
    v_mov_b32 v192, 0
    v_mov_b32 v193, 0
    v_mov_b32 v194, 0
    v_mov_b32 v195, 0
    v_mov_b32 v196, 0
    v_mov_b32 v197, 0
    v_mov_b32 v198, 0
    v_mov_b32 v199, 0
    v_mov_b32 v200, 0
    v_mov_b32 v201, 0
    v_mov_b32 v202, 0
    v_mov_b32 v203, 0
    v_mov_b32 v204, 0
    v_mov_b32 v205, 0
    v_mov_b32 v206, 0
    v_mov_b32 v207, 0
    v_mov_b32 v208, 0
    v_mov_b32 v209, 0
    v_mov_b32 v210, 0
    v_mov_b32 v211, 0
    v_mov_b32 v212, 0
    v_mov_b32 v213, 0
    v_mov_b32 v214, 0
    v_mov_b32 v215, 0
    v_mov_b32 v216, 0
    v_mov_b32 v217, 0
    v_mov_b32 v218, 0
    v_mov_b32 v219, 0
    v_mov_b32 v220, 0
    v_mov_b32 v221, 0
    v_mov_b32 v222, 0
    v_mov_b32 v223, 0
    v_mov_b32 v224, 0
    v_mov_b32 v225, 0
    v_mov_b32 v226, 0
    v_mov_b32 v227, 0
    v_mov_b32 v228, 0
    v_mov_b32 v229, 0
    v_mov_b32 v230, 0
    v_mov_b32 v231, 0
    v_mov_b32 v232, 0
    v_mov_b32 v233, 0
    v_mov_b32 v234, 0
    v_mov_b32 v235, 0
    v_mov_b32 v236, 0
    v_mov_b32 v237, 0
    v_mov_b32 v238, 0
    v_mov_b32 v239, 0
    v_mov_b32 v240, 0
    v_mov_b32 v241, 0
    v_mov_b32 v242, 0
    v_mov_b32 v243, 0
    v_mov_b32 v244, 0
    v_mov_b32 v245, 0
    v_mov_b32 v246, 0
    v_mov_b32 v247, 0
    v_mov_b32 v248, 0
    v_mov_b32 v249, 0
    v_mov_b32 v250, 0
    v_mov_b32 v251, 0
    v_mov_b32 v252, 0
    v_mov_b32 v253, 0
    v_mov_b32 v254, 0
    v_mov_b32 v255, 0
    s_mul_i32 s14, s3, 20480
    v_add_u32 v9, s14, v3
    s_waitcnt vmcnt(8) lgkmcnt(0)
    v_mfma_f32_16x16x32_bf16 v[176:179], v[48:51], v[32:35], v[176:179]
    v_mfma_f32_16x16x32_bf16 v[180:183], v[52:55], v[32:35], v[180:183]
    buffer_load_dwordx4 v[140:143], v3, s[48:51], s10 offen offset:0 sc1
    v_mfma_f32_16x16x32_bf16 v[184:187], v[56:59], v[32:35], v[184:187]
    v_mfma_f32_16x16x32_bf16 v[188:191], v[60:63], v[32:35], v[188:191]
    buffer_load_dwordx4 v[144:147], v3, s[48:51], s10 offen offset:1024 sc1
    v_mfma_f32_16x16x32_bf16 v[192:195], v[64:67], v[32:35], v[192:195]
    v_mfma_f32_16x16x32_bf16 v[196:199], v[48:51], v[36:39], v[196:199]
    buffer_load_dwordx4 v[148:151], v3, s[48:51], s10 offen offset:2048 sc1
    v_mfma_f32_16x16x32_bf16 v[200:203], v[52:55], v[36:39], v[200:203]
    v_mfma_f32_16x16x32_bf16 v[204:207], v[56:59], v[36:39], v[204:207]
    buffer_load_dwordx4 v[152:155], v3, s[48:51], s10 offen offset:3072 sc1
    v_mfma_f32_16x16x32_bf16 v[208:211], v[60:63], v[36:39], v[208:211]
    v_mfma_f32_16x16x32_bf16 v[212:215], v[64:67], v[36:39], v[212:215]
    ds_read_b128 v[156:159], v9 offset:0
    v_mfma_f32_16x16x32_bf16 v[216:219], v[48:51], v[40:43], v[216:219]
    v_mfma_f32_16x16x32_bf16 v[220:223], v[52:55], v[40:43], v[220:223]
    ds_read_b128 v[160:163], v9 offset:1024
    v_mfma_f32_16x16x32_bf16 v[224:227], v[56:59], v[40:43], v[224:227]
    v_mfma_f32_16x16x32_bf16 v[228:231], v[60:63], v[40:43], v[228:231]
    ds_read_b128 v[164:167], v9 offset:2048
    v_mfma_f32_16x16x32_bf16 v[232:235], v[64:67], v[40:43], v[232:235]
    v_mfma_f32_16x16x32_bf16 v[236:239], v[48:51], v[44:47], v[236:239]
    ds_read_b128 v[168:171], v9 offset:3072
    v_mfma_f32_16x16x32_bf16 v[240:243], v[52:55], v[44:47], v[240:243]
    v_mfma_f32_16x16x32_bf16 v[244:247], v[56:59], v[44:47], v[244:247]
    ds_read_b128 v[172:175], v9 offset:4096
    v_mfma_f32_16x16x32_bf16 v[248:251], v[60:63], v[44:47], v[248:251]
    v_mfma_f32_16x16x32_bf16 v[252:255], v[64:67], v[44:47], v[252:255]
    s_add_u32 s10, s10, 4096
    s_waitcnt vmcnt(8) lgkmcnt(0)
    v_mfma_f32_16x16x32_bf16 v[176:179], v[84:87], v[68:71], v[176:179]
    v_mfma_f32_16x16x32_bf16 v[180:183], v[88:91], v[68:71], v[180:183]
    buffer_load_dwordx4 v[32:35], v3, s[48:51], s10 offen offset:0 sc1
    v_mfma_f32_16x16x32_bf16 v[184:187], v[92:95], v[68:71], v[184:187]
    v_mfma_f32_16x16x32_bf16 v[188:191], v[96:99], v[68:71], v[188:191]
    buffer_load_dwordx4 v[36:39], v3, s[48:51], s10 offen offset:1024 sc1
    v_mfma_f32_16x16x32_bf16 v[192:195], v[100:103], v[68:71], v[192:195]
    v_mfma_f32_16x16x32_bf16 v[196:199], v[84:87], v[72:75], v[196:199]
    buffer_load_dwordx4 v[40:43], v3, s[48:51], s10 offen offset:2048 sc1
    v_mfma_f32_16x16x32_bf16 v[200:203], v[88:91], v[72:75], v[200:203]
    v_mfma_f32_16x16x32_bf16 v[204:207], v[92:95], v[72:75], v[204:207]
    buffer_load_dwordx4 v[44:47], v3, s[48:51], s10 offen offset:3072 sc1
    v_mfma_f32_16x16x32_bf16 v[208:211], v[96:99], v[72:75], v[208:211]
    v_mfma_f32_16x16x32_bf16 v[212:215], v[100:103], v[72:75], v[212:215]
    ds_read_b128 v[48:51], v9 offset:5120
    v_mfma_f32_16x16x32_bf16 v[216:219], v[84:87], v[76:79], v[216:219]
    v_mfma_f32_16x16x32_bf16 v[220:223], v[88:91], v[76:79], v[220:223]
    ds_read_b128 v[52:55], v9 offset:6144
    v_mfma_f32_16x16x32_bf16 v[224:227], v[92:95], v[76:79], v[224:227]
    v_mfma_f32_16x16x32_bf16 v[228:231], v[96:99], v[76:79], v[228:231]
    ds_read_b128 v[56:59], v9 offset:7168
    v_mfma_f32_16x16x32_bf16 v[232:235], v[100:103], v[76:79], v[232:235]
    v_mfma_f32_16x16x32_bf16 v[236:239], v[84:87], v[80:83], v[236:239]
    ds_read_b128 v[60:63], v9 offset:8192
    v_mfma_f32_16x16x32_bf16 v[240:243], v[88:91], v[80:83], v[240:243]
    v_mfma_f32_16x16x32_bf16 v[244:247], v[92:95], v[80:83], v[244:247]
    ds_read_b128 v[64:67], v9 offset:9216
    v_mfma_f32_16x16x32_bf16 v[248:251], v[96:99], v[80:83], v[248:251]
    v_mfma_f32_16x16x32_bf16 v[252:255], v[100:103], v[80:83], v[252:255]
    s_add_u32 s10, s10, 4096
    s_waitcnt vmcnt(8) lgkmcnt(0)
    v_mfma_f32_16x16x32_bf16 v[176:179], v[120:123], v[104:107], v[176:179]
    v_mfma_f32_16x16x32_bf16 v[180:183], v[124:127], v[104:107], v[180:183]
    buffer_load_dwordx4 v[68:71], v3, s[48:51], s10 offen offset:0 sc1
    v_mfma_f32_16x16x32_bf16 v[184:187], v[128:131], v[104:107], v[184:187]
    v_mfma_f32_16x16x32_bf16 v[188:191], v[132:135], v[104:107], v[188:191]
    buffer_load_dwordx4 v[72:75], v3, s[48:51], s10 offen offset:1024 sc1
    v_mfma_f32_16x16x32_bf16 v[192:195], v[136:139], v[104:107], v[192:195]
    v_mfma_f32_16x16x32_bf16 v[196:199], v[120:123], v[108:111], v[196:199]
    buffer_load_dwordx4 v[76:79], v3, s[48:51], s10 offen offset:2048 sc1
    v_mfma_f32_16x16x32_bf16 v[200:203], v[124:127], v[108:111], v[200:203]
    v_mfma_f32_16x16x32_bf16 v[204:207], v[128:131], v[108:111], v[204:207]
    buffer_load_dwordx4 v[80:83], v3, s[48:51], s10 offen offset:3072 sc1
    v_mfma_f32_16x16x32_bf16 v[208:211], v[132:135], v[108:111], v[208:211]
    v_mfma_f32_16x16x32_bf16 v[212:215], v[136:139], v[108:111], v[212:215]
    ds_read_b128 v[84:87], v9 offset:10240
    v_mfma_f32_16x16x32_bf16 v[216:219], v[120:123], v[112:115], v[216:219]
    v_mfma_f32_16x16x32_bf16 v[220:223], v[124:127], v[112:115], v[220:223]
    ds_read_b128 v[88:91], v9 offset:11264
    v_mfma_f32_16x16x32_bf16 v[224:227], v[128:131], v[112:115], v[224:227]
    v_mfma_f32_16x16x32_bf16 v[228:231], v[132:135], v[112:115], v[228:231]
    ds_read_b128 v[92:95], v9 offset:12288
    v_mfma_f32_16x16x32_bf16 v[232:235], v[136:139], v[112:115], v[232:235]
    v_mfma_f32_16x16x32_bf16 v[236:239], v[120:123], v[116:119], v[236:239]
    ds_read_b128 v[96:99], v9 offset:13312
    v_mfma_f32_16x16x32_bf16 v[240:243], v[124:127], v[116:119], v[240:243]
    v_mfma_f32_16x16x32_bf16 v[244:247], v[128:131], v[116:119], v[244:247]
    ds_read_b128 v[100:103], v9 offset:14336
    v_mfma_f32_16x16x32_bf16 v[248:251], v[132:135], v[116:119], v[248:251]
    v_mfma_f32_16x16x32_bf16 v[252:255], v[136:139], v[116:119], v[252:255]
    s_add_u32 s10, s10, 4096
    s_waitcnt vmcnt(8) lgkmcnt(0)
    v_mfma_f32_16x16x32_bf16 v[176:179], v[156:159], v[140:143], v[176:179]
    v_mfma_f32_16x16x32_bf16 v[180:183], v[160:163], v[140:143], v[180:183]
    buffer_load_dwordx4 v[104:107], v3, s[48:51], s10 offen offset:0 sc1
    v_mfma_f32_16x16x32_bf16 v[184:187], v[164:167], v[140:143], v[184:187]
    v_mfma_f32_16x16x32_bf16 v[188:191], v[168:171], v[140:143], v[188:191]
    buffer_load_dwordx4 v[108:111], v3, s[48:51], s10 offen offset:1024 sc1
    v_mfma_f32_16x16x32_bf16 v[192:195], v[172:175], v[140:143], v[192:195]
    v_mfma_f32_16x16x32_bf16 v[196:199], v[156:159], v[144:147], v[196:199]
    buffer_load_dwordx4 v[112:115], v3, s[48:51], s10 offen offset:2048 sc1
    v_mfma_f32_16x16x32_bf16 v[200:203], v[160:163], v[144:147], v[200:203]
    v_mfma_f32_16x16x32_bf16 v[204:207], v[164:167], v[144:147], v[204:207]
    buffer_load_dwordx4 v[116:119], v3, s[48:51], s10 offen offset:3072 sc1
    v_mfma_f32_16x16x32_bf16 v[208:211], v[168:171], v[144:147], v[208:211]
    v_mfma_f32_16x16x32_bf16 v[212:215], v[172:175], v[144:147], v[212:215]
    ds_read_b128 v[120:123], v9 offset:15360
    v_mfma_f32_16x16x32_bf16 v[216:219], v[156:159], v[148:151], v[216:219]
    v_mfma_f32_16x16x32_bf16 v[220:223], v[160:163], v[148:151], v[220:223]
    ds_read_b128 v[124:127], v9 offset:16384
    v_mfma_f32_16x16x32_bf16 v[224:227], v[164:167], v[148:151], v[224:227]
    v_mfma_f32_16x16x32_bf16 v[228:231], v[168:171], v[148:151], v[228:231]
    ds_read_b128 v[128:131], v9 offset:17408
    v_mfma_f32_16x16x32_bf16 v[232:235], v[172:175], v[148:151], v[232:235]
    v_mfma_f32_16x16x32_bf16 v[236:239], v[156:159], v[152:155], v[236:239]
    ds_read_b128 v[132:135], v9 offset:18432
    v_mfma_f32_16x16x32_bf16 v[240:243], v[160:163], v[152:155], v[240:243]
    v_mfma_f32_16x16x32_bf16 v[244:247], v[164:167], v[152:155], v[244:247]
    ds_read_b128 v[136:139], v9 offset:19456
    v_mfma_f32_16x16x32_bf16 v[248:251], v[168:171], v[152:155], v[248:251]
    v_mfma_f32_16x16x32_bf16 v[252:255], v[172:175], v[152:155], v[252:255]
    s_add_u32 s10, s10, 4096
    s_waitcnt vmcnt(8) lgkmcnt(0)
    v_mfma_f32_16x16x32_bf16 v[176:179], v[48:51], v[32:35], v[176:179]
    v_mfma_f32_16x16x32_bf16 v[180:183], v[52:55], v[32:35], v[180:183]
    buffer_load_dwordx4 v[140:143], v3, s[48:51], s10 offen offset:0 sc1
    v_mfma_f32_16x16x32_bf16 v[184:187], v[56:59], v[32:35], v[184:187]
    v_mfma_f32_16x16x32_bf16 v[188:191], v[60:63], v[32:35], v[188:191]
    buffer_load_dwordx4 v[144:147], v3, s[48:51], s10 offen offset:1024 sc1
    v_mfma_f32_16x16x32_bf16 v[192:195], v[64:67], v[32:35], v[192:195]
    v_mfma_f32_16x16x32_bf16 v[196:199], v[48:51], v[36:39], v[196:199]
    buffer_load_dwordx4 v[148:151], v3, s[48:51], s10 offen offset:2048 sc1
    v_mfma_f32_16x16x32_bf16 v[200:203], v[52:55], v[36:39], v[200:203]
    v_mfma_f32_16x16x32_bf16 v[204:207], v[56:59], v[36:39], v[204:207]
    buffer_load_dwordx4 v[152:155], v3, s[48:51], s10 offen offset:3072 sc1
    v_mfma_f32_16x16x32_bf16 v[208:211], v[60:63], v[36:39], v[208:211]
    v_mfma_f32_16x16x32_bf16 v[212:215], v[64:67], v[36:39], v[212:215]
    buffer_load_dwordx4 v[156:159], v3, s[52:55], s11 offen offset:0 sc1
    v_mfma_f32_16x16x32_bf16 v[216:219], v[48:51], v[40:43], v[216:219]
    v_mfma_f32_16x16x32_bf16 v[220:223], v[52:55], v[40:43], v[220:223]
    buffer_load_dwordx4 v[160:163], v3, s[52:55], s11 offen offset:1024 sc1
    v_mfma_f32_16x16x32_bf16 v[224:227], v[56:59], v[40:43], v[224:227]
    v_mfma_f32_16x16x32_bf16 v[228:231], v[60:63], v[40:43], v[228:231]
    buffer_load_dwordx4 v[164:167], v3, s[52:55], s11 offen offset:2048 sc1
    v_mfma_f32_16x16x32_bf16 v[232:235], v[64:67], v[40:43], v[232:235]
    v_mfma_f32_16x16x32_bf16 v[236:239], v[48:51], v[44:47], v[236:239]
    buffer_load_dwordx4 v[168:171], v3, s[52:55], s11 offen offset:3072 sc1
    v_mfma_f32_16x16x32_bf16 v[240:243], v[52:55], v[44:47], v[240:243]
    v_mfma_f32_16x16x32_bf16 v[244:247], v[56:59], v[44:47], v[244:247]
    buffer_load_dwordx4 v[172:175], v4, s[52:55], s11 offen sc1
    v_mfma_f32_16x16x32_bf16 v[248:251], v[60:63], v[44:47], v[248:251]
    v_mfma_f32_16x16x32_bf16 v[252:255], v[64:67], v[44:47], v[252:255]
    s_add_u32 s10, s10, 4096
    s_add_u32 s11, s11, 5120
    s_waitcnt vmcnt(13) lgkmcnt(0)
    v_mfma_f32_16x16x32_bf16 v[176:179], v[84:87], v[68:71], v[176:179]
    v_mfma_f32_16x16x32_bf16 v[180:183], v[88:91], v[68:71], v[180:183]
    buffer_load_dwordx4 v[32:35], v3, s[48:51], s10 offen offset:0 sc1
    v_mfma_f32_16x16x32_bf16 v[184:187], v[92:95], v[68:71], v[184:187]
    v_mfma_f32_16x16x32_bf16 v[188:191], v[96:99], v[68:71], v[188:191]
    buffer_load_dwordx4 v[36:39], v3, s[48:51], s10 offen offset:1024 sc1
    v_mfma_f32_16x16x32_bf16 v[192:195], v[100:103], v[68:71], v[192:195]
    v_mfma_f32_16x16x32_bf16 v[196:199], v[84:87], v[72:75], v[196:199]
    buffer_load_dwordx4 v[40:43], v3, s[48:51], s10 offen offset:2048 sc1
    v_mfma_f32_16x16x32_bf16 v[200:203], v[88:91], v[72:75], v[200:203]
    v_mfma_f32_16x16x32_bf16 v[204:207], v[92:95], v[72:75], v[204:207]
    buffer_load_dwordx4 v[44:47], v3, s[48:51], s10 offen offset:3072 sc1
    v_mfma_f32_16x16x32_bf16 v[208:211], v[96:99], v[72:75], v[208:211]
    v_mfma_f32_16x16x32_bf16 v[212:215], v[100:103], v[72:75], v[212:215]
    buffer_load_dwordx4 v[48:51], v3, s[52:55], s11 offen offset:0 sc1
    v_mfma_f32_16x16x32_bf16 v[216:219], v[84:87], v[76:79], v[216:219]
    v_mfma_f32_16x16x32_bf16 v[220:223], v[88:91], v[76:79], v[220:223]
    buffer_load_dwordx4 v[52:55], v3, s[52:55], s11 offen offset:1024 sc1
    v_mfma_f32_16x16x32_bf16 v[224:227], v[92:95], v[76:79], v[224:227]
    v_mfma_f32_16x16x32_bf16 v[228:231], v[96:99], v[76:79], v[228:231]
    buffer_load_dwordx4 v[56:59], v3, s[52:55], s11 offen offset:2048 sc1
    v_mfma_f32_16x16x32_bf16 v[232:235], v[100:103], v[76:79], v[232:235]
    v_mfma_f32_16x16x32_bf16 v[236:239], v[84:87], v[80:83], v[236:239]
    buffer_load_dwordx4 v[60:63], v3, s[52:55], s11 offen offset:3072 sc1
    v_mfma_f32_16x16x32_bf16 v[240:243], v[88:91], v[80:83], v[240:243]
    v_mfma_f32_16x16x32_bf16 v[244:247], v[92:95], v[80:83], v[244:247]
    buffer_load_dwordx4 v[64:67], v4, s[52:55], s11 offen sc1
    v_mfma_f32_16x16x32_bf16 v[248:251], v[96:99], v[80:83], v[248:251]
    v_mfma_f32_16x16x32_bf16 v[252:255], v[100:103], v[80:83], v[252:255]
    s_add_u32 s10, s10, 4096
    s_add_u32 s11, s11, 5120
    s_waitcnt vmcnt(18) lgkmcnt(0)
    v_mfma_f32_16x16x32_bf16 v[176:179], v[120:123], v[104:107], v[176:179]
    v_mfma_f32_16x16x32_bf16 v[180:183], v[124:127], v[104:107], v[180:183]
    buffer_load_dwordx4 v[68:71], v3, s[48:51], s10 offen offset:0 sc1
    v_mfma_f32_16x16x32_bf16 v[184:187], v[128:131], v[104:107], v[184:187]
    v_mfma_f32_16x16x32_bf16 v[188:191], v[132:135], v[104:107], v[188:191]
    buffer_load_dwordx4 v[72:75], v3, s[48:51], s10 offen offset:1024 sc1
    v_mfma_f32_16x16x32_bf16 v[192:195], v[136:139], v[104:107], v[192:195]
    v_mfma_f32_16x16x32_bf16 v[196:199], v[120:123], v[108:111], v[196:199]
    buffer_load_dwordx4 v[76:79], v3, s[48:51], s10 offen offset:2048 sc1
    v_mfma_f32_16x16x32_bf16 v[200:203], v[124:127], v[108:111], v[200:203]
    v_mfma_f32_16x16x32_bf16 v[204:207], v[128:131], v[108:111], v[204:207]
    buffer_load_dwordx4 v[80:83], v3, s[48:51], s10 offen offset:3072 sc1
    v_mfma_f32_16x16x32_bf16 v[208:211], v[132:135], v[108:111], v[208:211]
    v_mfma_f32_16x16x32_bf16 v[212:215], v[136:139], v[108:111], v[212:215]
    buffer_load_dwordx4 v[84:87], v3, s[52:55], s11 offen offset:0 sc1
    v_mfma_f32_16x16x32_bf16 v[216:219], v[120:123], v[112:115], v[216:219]
    v_mfma_f32_16x16x32_bf16 v[220:223], v[124:127], v[112:115], v[220:223]
    buffer_load_dwordx4 v[88:91], v3, s[52:55], s11 offen offset:1024 sc1
    v_mfma_f32_16x16x32_bf16 v[224:227], v[128:131], v[112:115], v[224:227]
    v_mfma_f32_16x16x32_bf16 v[228:231], v[132:135], v[112:115], v[228:231]
    buffer_load_dwordx4 v[92:95], v3, s[52:55], s11 offen offset:2048 sc1
    v_mfma_f32_16x16x32_bf16 v[232:235], v[136:139], v[112:115], v[232:235]
    v_mfma_f32_16x16x32_bf16 v[236:239], v[120:123], v[116:119], v[236:239]
    buffer_load_dwordx4 v[96:99], v3, s[52:55], s11 offen offset:3072 sc1
    v_mfma_f32_16x16x32_bf16 v[240:243], v[124:127], v[116:119], v[240:243]
    v_mfma_f32_16x16x32_bf16 v[244:247], v[128:131], v[116:119], v[244:247]
    buffer_load_dwordx4 v[100:103], v4, s[52:55], s11 offen sc1
    v_mfma_f32_16x16x32_bf16 v[248:251], v[132:135], v[116:119], v[248:251]
    v_mfma_f32_16x16x32_bf16 v[252:255], v[136:139], v[116:119], v[252:255]
    s_add_u32 s10, s10, 4096
    s_add_u32 s11, s11, 5120
    s_mov_b32 s72, 15
    s_sub_u32 s13, s12, 10
    s_sub_u32 s12, s12, 7
K2_LOOP:
    s_cmp_lg_u32 s13, 0
    s_cbranch_scc1 K2W_28
    s_waitcnt vmcnt(0)
K2W_28:
    s_waitcnt vmcnt(18)
    s_cmp_lg_u32 s13, 0
    s_cbranch_scc0 K2S_29
    v_mfma_f32_16x16x32_bf16 v[176:179], v[156:159], v[140:143], v[176:179]
    v_mfma_f32_16x16x32_bf16 v[180:183], v[160:163], v[140:143], v[180:183]
    buffer_load_dwordx4 v[104:107], v3, s[48:51], s10 offen offset:0 sc1
    v_mfma_f32_16x16x32_bf16 v[184:187], v[164:167], v[140:143], v[184:187]
    v_mfma_f32_16x16x32_bf16 v[188:191], v[168:171], v[140:143], v[188:191]
    buffer_load_dwordx4 v[108:111], v3, s[48:51], s10 offen offset:1024 sc1
    v_mfma_f32_16x16x32_bf16 v[192:195], v[172:175], v[140:143], v[192:195]
    v_mfma_f32_16x16x32_bf16 v[196:199], v[156:159], v[144:147], v[196:199]
    buffer_load_dwordx4 v[112:115], v3, s[48:51], s10 offen offset:2048 sc1
    v_mfma_f32_16x16x32_bf16 v[200:203], v[160:163], v[144:147], v[200:203]
    v_mfma_f32_16x16x32_bf16 v[204:207], v[164:167], v[144:147], v[204:207]
    buffer_load_dwordx4 v[116:119], v3, s[48:51], s10 offen offset:3072 sc1
    v_mfma_f32_16x16x32_bf16 v[208:211], v[168:171], v[144:147], v[208:211]
    v_mfma_f32_16x16x32_bf16 v[212:215], v[172:175], v[144:147], v[212:215]
    buffer_load_dwordx4 v[120:123], v3, s[52:55], s11 offen offset:0 sc1
    v_mfma_f32_16x16x32_bf16 v[216:219], v[156:159], v[148:151], v[216:219]
    v_mfma_f32_16x16x32_bf16 v[220:223], v[160:163], v[148:151], v[220:223]
    buffer_load_dwordx4 v[124:127], v3, s[52:55], s11 offen offset:1024 sc1
    v_mfma_f32_16x16x32_bf16 v[224:227], v[164:167], v[148:151], v[224:227]
    v_mfma_f32_16x16x32_bf16 v[228:231], v[168:171], v[148:151], v[228:231]
    buffer_load_dwordx4 v[128:131], v3, s[52:55], s11 offen offset:2048 sc1
    v_mfma_f32_16x16x32_bf16 v[232:235], v[172:175], v[148:151], v[232:235]
    v_mfma_f32_16x16x32_bf16 v[236:239], v[156:159], v[152:155], v[236:239]
    buffer_load_dwordx4 v[132:135], v3, s[52:55], s11 offen offset:3072 sc1
    v_mfma_f32_16x16x32_bf16 v[240:243], v[160:163], v[152:155], v[240:243]
    v_mfma_f32_16x16x32_bf16 v[244:247], v[164:167], v[152:155], v[244:247]
    buffer_load_dwordx4 v[136:139], v4, s[52:55], s11 offen sc1
    v_mfma_f32_16x16x32_bf16 v[248:251], v[168:171], v[152:155], v[248:251]
    v_mfma_f32_16x16x32_bf16 v[252:255], v[172:175], v[152:155], v[252:255]
    s_add_u32 s10, s10, 4096
    s_add_u32 s11, s11, 5120
    s_sub_u32 s13, s13, 1
    s_branch K2N_30
K2S_29:
    v_mfma_f32_16x16x32_bf16 v[176:179], v[156:159], v[140:143], v[176:179]
    v_mfma_f32_16x16x32_bf16 v[180:183], v[160:163], v[140:143], v[180:183]
    v_mfma_f32_16x16x32_bf16 v[184:187], v[164:167], v[140:143], v[184:187]
    v_mfma_f32_16x16x32_bf16 v[188:191], v[168:171], v[140:143], v[188:191]
    v_mfma_f32_16x16x32_bf16 v[192:195], v[172:175], v[140:143], v[192:195]
    v_mfma_f32_16x16x32_bf16 v[196:199], v[156:159], v[144:147], v[196:199]
    v_mfma_f32_16x16x32_bf16 v[200:203], v[160:163], v[144:147], v[200:203]
    v_mfma_f32_16x16x32_bf16 v[204:207], v[164:167], v[144:147], v[204:207]
    v_mfma_f32_16x16x32_bf16 v[208:211], v[168:171], v[144:147], v[208:211]
    v_mfma_f32_16x16x32_bf16 v[212:215], v[172:175], v[144:147], v[212:215]
    v_mfma_f32_16x16x32_bf16 v[216:219], v[156:159], v[148:151], v[216:219]
    v_mfma_f32_16x16x32_bf16 v[220:223], v[160:163], v[148:151], v[220:223]
    v_mfma_f32_16x16x32_bf16 v[224:227], v[164:167], v[148:151], v[224:227]
    v_mfma_f32_16x16x32_bf16 v[228:231], v[168:171], v[148:151], v[228:231]
    v_mfma_f32_16x16x32_bf16 v[232:235], v[172:175], v[148:151], v[232:235]
    v_mfma_f32_16x16x32_bf16 v[236:239], v[156:159], v[152:155], v[236:239]
    v_mfma_f32_16x16x32_bf16 v[240:243], v[160:163], v[152:155], v[240:243]
    v_mfma_f32_16x16x32_bf16 v[244:247], v[164:167], v[152:155], v[244:247]
    v_mfma_f32_16x16x32_bf16 v[248:251], v[168:171], v[152:155], v[248:251]
    v_mfma_f32_16x16x32_bf16 v[252:255], v[172:175], v[152:155], v[252:255]
K2N_30:
    s_sub_u32 s12, s12, 1
    s_cmp_lg_u32 s12, 0
    s_cbranch_scc0 K2_DONE
    s_cmp_lg_u32 s13, 0
    s_cbranch_scc1 K2W_31
    s_waitcnt vmcnt(0)
K2W_31:
    s_waitcnt vmcnt(18)
    s_cmp_lg_u32 s13, 0
    s_cbranch_scc0 K2S_32
    v_mfma_f32_16x16x32_bf16 v[176:179], v[48:51], v[32:35], v[176:179]
    v_mfma_f32_16x16x32_bf16 v[180:183], v[52:55], v[32:35], v[180:183]
    buffer_load_dwordx4 v[140:143], v3, s[48:51], s10 offen offset:0 sc1
    v_mfma_f32_16x16x32_bf16 v[184:187], v[56:59], v[32:35], v[184:187]
    v_mfma_f32_16x16x32_bf16 v[188:191], v[60:63], v[32:35], v[188:191]
    buffer_load_dwordx4 v[144:147], v3, s[48:51], s10 offen offset:1024 sc1
    v_mfma_f32_16x16x32_bf16 v[192:195], v[64:67], v[32:35], v[192:195]
    v_mfma_f32_16x16x32_bf16 v[196:199], v[48:51], v[36:39], v[196:199]
    buffer_load_dwordx4 v[148:151], v3, s[48:51], s10 offen offset:2048 sc1
    v_mfma_f32_16x16x32_bf16 v[200:203], v[52:55], v[36:39], v[200:203]
    v_mfma_f32_16x16x32_bf16 v[204:207], v[56:59], v[36:39], v[204:207]
    buffer_load_dwordx4 v[152:155], v3, s[48:51], s10 offen offset:3072 sc1
    v_mfma_f32_16x16x32_bf16 v[208:211], v[60:63], v[36:39], v[208:211]
    v_mfma_f32_16x16x32_bf16 v[212:215], v[64:67], v[36:39], v[212:215]
    buffer_load_dwordx4 v[156:159], v3, s[52:55], s11 offen offset:0 sc1
    v_mfma_f32_16x16x32_bf16 v[216:219], v[48:51], v[40:43], v[216:219]
    v_mfma_f32_16x16x32_bf16 v[220:223], v[52:55], v[40:43], v[220:223]
    buffer_load_dwordx4 v[160:163], v3, s[52:55], s11 offen offset:1024 sc1
    v_mfma_f32_16x16x32_bf16 v[224:227], v[56:59], v[40:43], v[224:227]
    v_mfma_f32_16x16x32_bf16 v[228:231], v[60:63], v[40:43], v[228:231]
    buffer_load_dwordx4 v[164:167], v3, s[52:55], s11 offen offset:2048 sc1
    v_mfma_f32_16x16x32_bf16 v[232:235], v[64:67], v[40:43], v[232:235]
    v_mfma_f32_16x16x32_bf16 v[236:239], v[48:51], v[44:47], v[236:239]
    buffer_load_dwordx4 v[168:171], v3, s[52:55], s11 offen offset:3072 sc1
    v_mfma_f32_16x16x32_bf16 v[240:243], v[52:55], v[44:47], v[240:243]
    v_mfma_f32_16x16x32_bf16 v[244:247], v[56:59], v[44:47], v[244:247]
    buffer_load_dwordx4 v[172:175], v4, s[52:55], s11 offen sc1
    v_mfma_f32_16x16x32_bf16 v[248:251], v[60:63], v[44:47], v[248:251]
    v_mfma_f32_16x16x32_bf16 v[252:255], v[64:67], v[44:47], v[252:255]
    s_add_u32 s10, s10, 4096
    s_add_u32 s11, s11, 5120
    s_sub_u32 s13, s13, 1
    s_branch K2N_33
K2S_32:
    v_mfma_f32_16x16x32_bf16 v[176:179], v[48:51], v[32:35], v[176:179]
    v_mfma_f32_16x16x32_bf16 v[180:183], v[52:55], v[32:35], v[180:183]
    v_mfma_f32_16x16x32_bf16 v[184:187], v[56:59], v[32:35], v[184:187]
    v_mfma_f32_16x16x32_bf16 v[188:191], v[60:63], v[32:35], v[188:191]
    v_mfma_f32_16x16x32_bf16 v[192:195], v[64:67], v[32:35], v[192:195]
    v_mfma_f32_16x16x32_bf16 v[196:199], v[48:51], v[36:39], v[196:199]
    v_mfma_f32_16x16x32_bf16 v[200:203], v[52:55], v[36:39], v[200:203]
    v_mfma_f32_16x16x32_bf16 v[204:207], v[56:59], v[36:39], v[204:207]
    v_mfma_f32_16x16x32_bf16 v[208:211], v[60:63], v[36:39], v[208:211]
    v_mfma_f32_16x16x32_bf16 v[212:215], v[64:67], v[36:39], v[212:215]
    v_mfma_f32_16x16x32_bf16 v[216:219], v[48:51], v[40:43], v[216:219]
    v_mfma_f32_16x16x32_bf16 v[220:223], v[52:55], v[40:43], v[220:223]
    v_mfma_f32_16x16x32_bf16 v[224:227], v[56:59], v[40:43], v[224:227]
    v_mfma_f32_16x16x32_bf16 v[228:231], v[60:63], v[40:43], v[228:231]
    v_mfma_f32_16x16x32_bf16 v[232:235], v[64:67], v[40:43], v[232:235]
    v_mfma_f32_16x16x32_bf16 v[236:239], v[48:51], v[44:47], v[236:239]
    v_mfma_f32_16x16x32_bf16 v[240:243], v[52:55], v[44:47], v[240:243]
    v_mfma_f32_16x16x32_bf16 v[244:247], v[56:59], v[44:47], v[244:247]
    v_mfma_f32_16x16x32_bf16 v[248:251], v[60:63], v[44:47], v[248:251]
    v_mfma_f32_16x16x32_bf16 v[252:255], v[64:67], v[44:47], v[252:255]
K2N_33:
    s_sub_u32 s12, s12, 1
    s_cmp_lg_u32 s12, 0
    s_cbranch_scc0 K2_DONE
    s_cmp_lg_u32 s13, 0
    s_cbranch_scc1 K2W_34
    s_waitcnt vmcnt(0)
K2W_34:
    s_waitcnt vmcnt(18)
    s_cmp_lg_u32 s13, 0
    s_cbranch_scc0 K2S_35
    v_mfma_f32_16x16x32_bf16 v[176:179], v[84:87], v[68:71], v[176:179]
    v_mfma_f32_16x16x32_bf16 v[180:183], v[88:91], v[68:71], v[180:183]
    buffer_load_dwordx4 v[32:35], v3, s[48:51], s10 offen offset:0 sc1
    v_mfma_f32_16x16x32_bf16 v[184:187], v[92:95], v[68:71], v[184:187]
    v_mfma_f32_16x16x32_bf16 v[188:191], v[96:99], v[68:71], v[188:191]
    buffer_load_dwordx4 v[36:39], v3, s[48:51], s10 offen offset:1024 sc1
    v_mfma_f32_16x16x32_bf16 v[192:195], v[100:103], v[68:71], v[192:195]
    v_mfma_f32_16x16x32_bf16 v[196:199], v[84:87], v[72:75], v[196:199]
    buffer_load_dwordx4 v[40:43], v3, s[48:51], s10 offen offset:2048 sc1
    v_mfma_f32_16x16x32_bf16 v[200:203], v[88:91], v[72:75], v[200:203]
    v_mfma_f32_16x16x32_bf16 v[204:207], v[92:95], v[72:75], v[204:207]
    buffer_load_dwordx4 v[44:47], v3, s[48:51], s10 offen offset:3072 sc1
    v_mfma_f32_16x16x32_bf16 v[208:211], v[96:99], v[72:75], v[208:211]
    v_mfma_f32_16x16x32_bf16 v[212:215], v[100:103], v[72:75], v[212:215]
    buffer_load_dwordx4 v[48:51], v3, s[52:55], s11 offen offset:0 sc1
    v_mfma_f32_16x16x32_bf16 v[216:219], v[84:87], v[76:79], v[216:219]
    v_mfma_f32_16x16x32_bf16 v[220:223], v[88:91], v[76:79], v[220:223]
    buffer_load_dwordx4 v[52:55], v3, s[52:55], s11 offen offset:1024 sc1
    v_mfma_f32_16x16x32_bf16 v[224:227], v[92:95], v[76:79], v[224:227]
    v_mfma_f32_16x16x32_bf16 v[228:231], v[96:99], v[76:79], v[228:231]
    buffer_load_dwordx4 v[56:59], v3, s[52:55], s11 offen offset:2048 sc1
    v_mfma_f32_16x16x32_bf16 v[232:235], v[100:103], v[76:79], v[232:235]
    v_mfma_f32_16x16x32_bf16 v[236:239], v[84:87], v[80:83], v[236:239]
    buffer_load_dwordx4 v[60:63], v3, s[52:55], s11 offen offset:3072 sc1
    v_mfma_f32_16x16x32_bf16 v[240:243], v[88:91], v[80:83], v[240:243]
    v_mfma_f32_16x16x32_bf16 v[244:247], v[92:95], v[80:83], v[244:247]
    buffer_load_dwordx4 v[64:67], v4, s[52:55], s11 offen sc1
    v_mfma_f32_16x16x32_bf16 v[248:251], v[96:99], v[80:83], v[248:251]
    v_mfma_f32_16x16x32_bf16 v[252:255], v[100:103], v[80:83], v[252:255]
    s_add_u32 s10, s10, 4096
    s_add_u32 s11, s11, 5120
    s_sub_u32 s13, s13, 1
    s_branch K2N_36
K2S_35:
    v_mfma_f32_16x16x32_bf16 v[176:179], v[84:87], v[68:71], v[176:179]
    v_mfma_f32_16x16x32_bf16 v[180:183], v[88:91], v[68:71], v[180:183]
    v_mfma_f32_16x16x32_bf16 v[184:187], v[92:95], v[68:71], v[184:187]
    v_mfma_f32_16x16x32_bf16 v[188:191], v[96:99], v[68:71], v[188:191]
    v_mfma_f32_16x16x32_bf16 v[192:195], v[100:103], v[68:71], v[192:195]
    v_mfma_f32_16x16x32_bf16 v[196:199], v[84:87], v[72:75], v[196:199]
    v_mfma_f32_16x16x32_bf16 v[200:203], v[88:91], v[72:75], v[200:203]
    v_mfma_f32_16x16x32_bf16 v[204:207], v[92:95], v[72:75], v[204:207]
    v_mfma_f32_16x16x32_bf16 v[208:211], v[96:99], v[72:75], v[208:211]
    v_mfma_f32_16x16x32_bf16 v[212:215], v[100:103], v[72:75], v[212:215]
    v_mfma_f32_16x16x32_bf16 v[216:219], v[84:87], v[76:79], v[216:219]
    v_mfma_f32_16x16x32_bf16 v[220:223], v[88:91], v[76:79], v[220:223]
    v_mfma_f32_16x16x32_bf16 v[224:227], v[92:95], v[76:79], v[224:227]
    v_mfma_f32_16x16x32_bf16 v[228:231], v[96:99], v[76:79], v[228:231]
    v_mfma_f32_16x16x32_bf16 v[232:235], v[100:103], v[76:79], v[232:235]
    v_mfma_f32_16x16x32_bf16 v[236:239], v[84:87], v[80:83], v[236:239]
    v_mfma_f32_16x16x32_bf16 v[240:243], v[88:91], v[80:83], v[240:243]
    v_mfma_f32_16x16x32_bf16 v[244:247], v[92:95], v[80:83], v[244:247]
    v_mfma_f32_16x16x32_bf16 v[248:251], v[96:99], v[80:83], v[248:251]
    v_mfma_f32_16x16x32_bf16 v[252:255], v[100:103], v[80:83], v[252:255]
K2N_36:
    s_sub_u32 s12, s12, 1
    s_cmp_lg_u32 s12, 0
    s_cbranch_scc0 K2_DONE
    s_cmp_lg_u32 s13, 0
    s_cbranch_scc1 K2W_37
    s_waitcnt vmcnt(0)
K2W_37:
    s_waitcnt vmcnt(18)
    s_cmp_lg_u32 s13, 0
    s_cbranch_scc0 K2S_38
    v_mfma_f32_16x16x32_bf16 v[176:179], v[120:123], v[104:107], v[176:179]
    v_mfma_f32_16x16x32_bf16 v[180:183], v[124:127], v[104:107], v[180:183]
    buffer_load_dwordx4 v[68:71], v3, s[48:51], s10 offen offset:0 sc1
    v_mfma_f32_16x16x32_bf16 v[184:187], v[128:131], v[104:107], v[184:187]
    v_mfma_f32_16x16x32_bf16 v[188:191], v[132:135], v[104:107], v[188:191]
    buffer_load_dwordx4 v[72:75], v3, s[48:51], s10 offen offset:1024 sc1
    v_mfma_f32_16x16x32_bf16 v[192:195], v[136:139], v[104:107], v[192:195]
    v_mfma_f32_16x16x32_bf16 v[196:199], v[120:123], v[108:111], v[196:199]
    buffer_load_dwordx4 v[76:79], v3, s[48:51], s10 offen offset:2048 sc1
    v_mfma_f32_16x16x32_bf16 v[200:203], v[124:127], v[108:111], v[200:203]
    v_mfma_f32_16x16x32_bf16 v[204:207], v[128:131], v[108:111], v[204:207]
    buffer_load_dwordx4 v[80:83], v3, s[48:51], s10 offen offset:3072 sc1
    v_mfma_f32_16x16x32_bf16 v[208:211], v[132:135], v[108:111], v[208:211]
    v_mfma_f32_16x16x32_bf16 v[212:215], v[136:139], v[108:111], v[212:215]
    buffer_load_dwordx4 v[84:87], v3, s[52:55], s11 offen offset:0 sc1
    v_mfma_f32_16x16x32_bf16 v[216:219], v[120:123], v[112:115], v[216:219]
    v_mfma_f32_16x16x32_bf16 v[220:223], v[124:127], v[112:115], v[220:223]
    buffer_load_dwordx4 v[88:91], v3, s[52:55], s11 offen offset:1024 sc1
    v_mfma_f32_16x16x32_bf16 v[224:227], v[128:131], v[112:115], v[224:227]
    v_mfma_f32_16x16x32_bf16 v[228:231], v[132:135], v[112:115], v[228:231]
    buffer_load_dwordx4 v[92:95], v3, s[52:55], s11 offen offset:2048 sc1
    v_mfma_f32_16x16x32_bf16 v[232:235], v[136:139], v[112:115], v[232:235]
    v_mfma_f32_16x16x32_bf16 v[236:239], v[120:123], v[116:119], v[236:239]
    buffer_load_dwordx4 v[96:99], v3, s[52:55], s11 offen offset:3072 sc1
    v_mfma_f32_16x16x32_bf16 v[240:243], v[124:127], v[116:119], v[240:243]
    v_mfma_f32_16x16x32_bf16 v[244:247], v[128:131], v[116:119], v[244:247]
    buffer_load_dwordx4 v[100:103], v4, s[52:55], s11 offen sc1
    v_mfma_f32_16x16x32_bf16 v[248:251], v[132:135], v[116:119], v[248:251]
    v_mfma_f32_16x16x32_bf16 v[252:255], v[136:139], v[116:119], v[252:255]
    s_add_u32 s10, s10, 4096
    s_add_u32 s11, s11, 5120
    s_sub_u32 s13, s13, 1
    s_branch K2N_39
K2S_38:
    v_mfma_f32_16x16x32_bf16 v[176:179], v[120:123], v[104:107], v[176:179]
    v_mfma_f32_16x16x32_bf16 v[180:183], v[124:127], v[104:107], v[180:183]
    v_mfma_f32_16x16x32_bf16 v[184:187], v[128:131], v[104:107], v[184:187]
    v_mfma_f32_16x16x32_bf16 v[188:191], v[132:135], v[104:107], v[188:191]
    v_mfma_f32_16x16x32_bf16 v[192:195], v[136:139], v[104:107], v[192:195]
    v_mfma_f32_16x16x32_bf16 v[196:199], v[120:123], v[108:111], v[196:199]
    v_mfma_f32_16x16x32_bf16 v[200:203], v[124:127], v[108:111], v[200:203]
    v_mfma_f32_16x16x32_bf16 v[204:207], v[128:131], v[108:111], v[204:207]
    v_mfma_f32_16x16x32_bf16 v[208:211], v[132:135], v[108:111], v[208:211]
    v_mfma_f32_16x16x32_bf16 v[212:215], v[136:139], v[108:111], v[212:215]
    v_mfma_f32_16x16x32_bf16 v[216:219], v[120:123], v[112:115], v[216:219]
    v_mfma_f32_16x16x32_bf16 v[220:223], v[124:127], v[112:115], v[220:223]
    v_mfma_f32_16x16x32_bf16 v[224:227], v[128:131], v[112:115], v[224:227]
    v_mfma_f32_16x16x32_bf16 v[228:231], v[132:135], v[112:115], v[228:231]
    v_mfma_f32_16x16x32_bf16 v[232:235], v[136:139], v[112:115], v[232:235]
    v_mfma_f32_16x16x32_bf16 v[236:239], v[120:123], v[116:119], v[236:239]
    v_mfma_f32_16x16x32_bf16 v[240:243], v[124:127], v[116:119], v[240:243]
    v_mfma_f32_16x16x32_bf16 v[244:247], v[128:131], v[116:119], v[244:247]
    v_mfma_f32_16x16x32_bf16 v[248:251], v[132:135], v[116:119], v[248:251]
    v_mfma_f32_16x16x32_bf16 v[252:255], v[136:139], v[116:119], v[252:255]
K2N_39:
    s_sub_u32 s12, s12, 1
    s_cmp_lg_u32 s12, 0
    s_cbranch_scc1 K2_LOOP
K2_DONE:
    s_setprio 0
    v_add_u32 v6, 0, v0
    s_mov_b32 s14, 214748365
    v_mul_hi_u32 v7, v6, s14
    v_mul_u32_u24 v8, 20, v7
    v_sub_u32 v8, v6, v8
    v_bfe_u32 v9, v7, 1, 2
    v_xor_b32 v9, v9, v8
    v_mul_u32_u24 v16, 320, v7
    v_lshl_add_u32 v16, v9, 4, v16
    s_lshl_b32 s15, s6, 6
    v_add_u32 v7, s15, v7
    s_mul_i32 s15, s7, 80
    v_lshl_add_u32 v8, v8, 2, s15
    v_mul_u32_u24 v9, 640, v7
    v_add_u32 v9, v9, v8
    v_lshlrev_b32 v20, 2, v9
    v_lshlrev_b32 v9, 1, v9
    v_lshlrev_b32 v8, 1, v8
    v_lshlrev_b32 v7, 4, v7
    buffer_load_dwordx2 v[32:33], v9, s[56:59], 0 offen
    buffer_load_dwordx2 v[34:35], v7, s[60:63], 0 offen sc1
    buffer_load_dwordx2 v[36:37], v8, s[64:67], 0 offen
    v_add_u32 v6, 512, v0
    s_mov_b32 s14, 214748365
    v_mul_hi_u32 v7, v6, s14
    v_mul_u32_u24 v8, 20, v7
    v_sub_u32 v8, v6, v8
    v_bfe_u32 v9, v7, 1, 2
    v_xor_b32 v9, v9, v8
    v_mul_u32_u24 v17, 320, v7
    v_lshl_add_u32 v17, v9, 4, v17
    s_lshl_b32 s15, s6, 6
    v_add_u32 v7, s15, v7
    s_mul_i32 s15, s7, 80
    v_lshl_add_u32 v8, v8, 2, s15
    v_mul_u32_u24 v9, 640, v7
    v_add_u32 v9, v9, v8
    v_lshlrev_b32 v21, 2, v9
    v_lshlrev_b32 v9, 1, v9
    v_lshlrev_b32 v8, 1, v8
    v_lshlrev_b32 v7, 4, v7
    buffer_load_dwordx2 v[38:39], v9, s[56:59], 0 offen
    buffer_load_dwordx2 v[40:41], v7, s[60:63], 0 offen sc1
    buffer_load_dwordx2 v[42:43], v8, s[64:67], 0 offen
    v_add_u32 v6, 1024, v0
    s_mov_b32 s14, 214748365
    v_mul_hi_u32 v7, v6, s14
    v_mul_u32_u24 v8, 20, v7
    v_sub_u32 v8, v6, v8
    v_bfe_u32 v9, v7, 1, 2
    v_xor_b32 v9, v9, v8
    v_mul_u32_u24 v18, 320, v7
    v_lshl_add_u32 v18, v9, 4, v18
    s_lshl_b32 s15, s6, 6
    v_add_u32 v7, s15, v7
    s_mul_i32 s15, s7, 80
    v_lshl_add_u32 v8, v8, 2, s15
    v_mul_u32_u24 v9, 640, v7
    v_add_u32 v9, v9, v8
    v_lshlrev_b32 v22, 2, v9
    v_lshlrev_b32 v9, 1, v9
    v_lshlrev_b32 v8, 1, v8
    v_lshlrev_b32 v7, 4, v7
    buffer_load_dwordx2 v[44:45], v9, s[56:59], 0 offen
    buffer_load_dwordx2 v[46:47], v7, s[60:63], 0 offen sc1
    buffer_load_dwordx2 v[48:49], v8, s[64:67], 0 offen
    v_and_b32 v5, 15, v2
    v_bfe_u32 v7, v2, 1, 2
    v_lshrrev_b32 v6, 4, v2
    v_xor_b32 v6, v6, v7
    v_mul_u32_u24 v5, 320, v5
    v_lshl_add_u32 v5, v6, 4, v5
    s_mul_i32 s14, s3, 20480
    v_add_u32 v5, s14, v5
    s_nop 3
    ds_write_b128 v5, v[176:179] offset:0
    ds_write_b128 v5, v[180:183] offset:64
    ds_write_b128 v5, v[184:187] offset:128
    ds_write_b128 v5, v[188:191] offset:192
    ds_write_b128 v5, v[192:195] offset:256
    ds_write_b128 v5, v[196:199] offset:5120
    ds_write_b128 v5, v[200:203] offset:5184
    ds_write_b128 v5, v[204:207] offset:5248
    ds_write_b128 v5, v[208:211] offset:5312
    ds_write_b128 v5, v[212:215] offset:5376
    ds_write_b128 v5, v[216:219] offset:10240
    ds_write_b128 v5, v[220:223] offset:10304
    ds_write_b128 v5, v[224:227] offset:10368
    ds_write_b128 v5, v[228:231] offset:10432
    ds_write_b128 v5, v[232:235] offset:10496
    ds_write_b128 v5, v[236:239] offset:15360
    ds_write_b128 v5, v[240:243] offset:15424
    ds_write_b128 v5, v[244:247] offset:15488
    ds_write_b128 v5, v[248:251] offset:15552
    ds_write_b128 v5, v[252:255] offset:15616
    s_waitcnt lgkmcnt(0)
    s_barrier
    v_add_u32 v26, 61440, v16
    v_add_u32 v27, 122880, v16
    ds_read_b128 v[64:67], v16 offset:0
    ds_read_b128 v[68:71], v16 offset:20480
    ds_read_b128 v[72:75], v16 offset:40960
    ds_read_b128 v[76:79], v26 offset:0
    ds_read_b128 v[80:83], v26 offset:20480
    ds_read_b128 v[84:87], v26 offset:40960
    ds_read_b128 v[88:91], v27 offset:0
    ds_read_b128 v[92:95], v27 offset:20480
    s_waitcnt vmcnt(0) lgkmcnt(0)
    v_add_f32 v64, v64, v68
    v_add_f32 v72, v72, v76
    v_add_f32 v80, v80, v84
    v_add_f32 v88, v88, v92
    v_add_f32 v64, v64, v72
    v_add_f32 v80, v80, v88
    v_lshlrev_b32 v10, 16, v32
    v_lshlrev_b32 v12, 16, v36
    v_sub_f32 v11, v10, v34
    v_mul_f32 v13, 0xbfb8aa3b, v64
    v_exp_f32 v13, v13
    v_mul_f32 v11, v11, v35
    v_add_f32 v13, 1.0, v13
    v_rcp_f32 v13, v13
    v_fmac_f32 v80, v11, v12
    v_mul_f32 v13, v13, v64
    v_fma_f32 v96, v80, v13, v10
    v_add_f32 v65, v65, v69
    v_add_f32 v73, v73, v77
    v_add_f32 v81, v81, v85
    v_add_f32 v89, v89, v93
    v_add_f32 v65, v65, v73
    v_add_f32 v81, v81, v89
    v_and_b32 v10, 0xffff0000, v32
    v_and_b32 v12, 0xffff0000, v36
    v_sub_f32 v11, v10, v34
    v_mul_f32 v13, 0xbfb8aa3b, v65
    v_exp_f32 v13, v13
    v_mul_f32 v11, v11, v35
    v_add_f32 v13, 1.0, v13
    v_rcp_f32 v13, v13
    v_fmac_f32 v81, v11, v12
    v_mul_f32 v13, v13, v65
    v_fma_f32 v97, v81, v13, v10
    v_add_f32 v66, v66, v70
    v_add_f32 v74, v74, v78
    v_add_f32 v82, v82, v86
    v_add_f32 v90, v90, v94
    v_add_f32 v66, v66, v74
    v_add_f32 v82, v82, v90
    v_lshlrev_b32 v10, 16, v33
    v_lshlrev_b32 v12, 16, v37
    v_sub_f32 v11, v10, v34
    v_mul_f32 v13, 0xbfb8aa3b, v66
    v_exp_f32 v13, v13
    v_mul_f32 v11, v11, v35
    v_add_f32 v13, 1.0, v13
    v_rcp_f32 v13, v13
    v_fmac_f32 v82, v11, v12
    v_mul_f32 v13, v13, v66
    v_fma_f32 v98, v82, v13, v10
    v_add_f32 v67, v67, v71
    v_add_f32 v75, v75, v79
    v_add_f32 v83, v83, v87
    v_add_f32 v91, v91, v95
    v_add_f32 v67, v67, v75
    v_add_f32 v83, v83, v91
    v_and_b32 v10, 0xffff0000, v33
    v_and_b32 v12, 0xffff0000, v37
    v_sub_f32 v11, v10, v34
    v_mul_f32 v13, 0xbfb8aa3b, v67
    v_exp_f32 v13, v13
    v_mul_f32 v11, v11, v35
    v_add_f32 v13, 1.0, v13
    v_rcp_f32 v13, v13
    v_fmac_f32 v83, v11, v12
    v_mul_f32 v13, v13, v67
    v_fma_f32 v99, v83, v13, v10
    buffer_store_dwordx4 v[96:99], v20, s[68:71], 0 offen sc1
    s_nop 1
    v_add_u32 v26, 61440, v17
    v_add_u32 v27, 122880, v17
    ds_read_b128 v[64:67], v17 offset:0
    ds_read_b128 v[68:71], v17 offset:20480
    ds_read_b128 v[72:75], v17 offset:40960
    ds_read_b128 v[76:79], v26 offset:0
    ds_read_b128 v[80:83], v26 offset:20480
    ds_read_b128 v[84:87], v26 offset:40960
    ds_read_b128 v[88:91], v27 offset:0
    ds_read_b128 v[92:95], v27 offset:20480
    s_waitcnt lgkmcnt(0)
    v_add_f32 v64, v64, v68
    v_add_f32 v72, v72, v76
    v_add_f32 v80, v80, v84
    v_add_f32 v88, v88, v92
    v_add_f32 v64, v64, v72
    v_add_f32 v80, v80, v88
    v_lshlrev_b32 v10, 16, v38
    v_lshlrev_b32 v12, 16, v42
    v_sub_f32 v11, v10, v40
    v_mul_f32 v13, 0xbfb8aa3b, v64
    v_exp_f32 v13, v13
    v_mul_f32 v11, v11, v41
    v_add_f32 v13, 1.0, v13
    v_rcp_f32 v13, v13
    v_fmac_f32 v80, v11, v12
    v_mul_f32 v13, v13, v64
    v_fma_f32 v96, v80, v13, v10
    v_add_f32 v65, v65, v69
    v_add_f32 v73, v73, v77
    v_add_f32 v81, v81, v85
    v_add_f32 v89, v89, v93
    v_add_f32 v65, v65, v73
    v_add_f32 v81, v81, v89
    v_and_b32 v10, 0xffff0000, v38
    v_and_b32 v12, 0xffff0000, v42
    v_sub_f32 v11, v10, v40
    v_mul_f32 v13, 0xbfb8aa3b, v65
    v_exp_f32 v13, v13
    v_mul_f32 v11, v11, v41
    v_add_f32 v13, 1.0, v13
    v_rcp_f32 v13, v13
    v_fmac_f32 v81, v11, v12
    v_mul_f32 v13, v13, v65
    v_fma_f32 v97, v81, v13, v10
    v_add_f32 v66, v66, v70
    v_add_f32 v74, v74, v78
    v_add_f32 v82, v82, v86
    v_add_f32 v90, v90, v94
    v_add_f32 v66, v66, v74
    v_add_f32 v82, v82, v90
    v_lshlrev_b32 v10, 16, v39
    v_lshlrev_b32 v12, 16, v43
    v_sub_f32 v11, v10, v40
    v_mul_f32 v13, 0xbfb8aa3b, v66
    v_exp_f32 v13, v13
    v_mul_f32 v11, v11, v41
    v_add_f32 v13, 1.0, v13
    v_rcp_f32 v13, v13
    v_fmac_f32 v82, v11, v12
    v_mul_f32 v13, v13, v66
    v_fma_f32 v98, v82, v13, v10
    v_add_f32 v67, v67, v71
    v_add_f32 v75, v75, v79
    v_add_f32 v83, v83, v87
    v_add_f32 v91, v91, v95
    v_add_f32 v67, v67, v75
    v_add_f32 v83, v83, v91
    v_and_b32 v10, 0xffff0000, v39
    v_and_b32 v12, 0xffff0000, v43
    v_sub_f32 v11, v10, v40
    v_mul_f32 v13, 0xbfb8aa3b, v67
    v_exp_f32 v13, v13
    v_mul_f32 v11, v11, v41
    v_add_f32 v13, 1.0, v13
    v_rcp_f32 v13, v13
    v_fmac_f32 v83, v11, v12
    v_mul_f32 v13, v13, v67
    v_fma_f32 v99, v83, v13, v10
    buffer_store_dwordx4 v[96:99], v21, s[68:71], 0 offen sc1
    s_nop 1
    s_cmp_ge_u32 s3, 4
    s_cbranch_scc1 K2_FIN
    v_add_u32 v26, 61440, v18
    v_add_u32 v27, 122880, v18
    ds_read_b128 v[64:67], v18 offset:0
    ds_read_b128 v[68:71], v18 offset:20480
    ds_read_b128 v[72:75], v18 offset:40960
    ds_read_b128 v[76:79], v26 offset:0
    ds_read_b128 v[80:83], v26 offset:20480
    ds_read_b128 v[84:87], v26 offset:40960
    ds_read_b128 v[88:91], v27 offset:0
    ds_read_b128 v[92:95], v27 offset:20480
    s_waitcnt lgkmcnt(0)
    v_add_f32 v64, v64, v68
    v_add_f32 v72, v72, v76
    v_add_f32 v80, v80, v84
    v_add_f32 v88, v88, v92
    v_add_f32 v64, v64, v72
    v_add_f32 v80, v80, v88
    v_lshlrev_b32 v10, 16, v44
    v_lshlrev_b32 v12, 16, v48
    v_sub_f32 v11, v10, v46
    v_mul_f32 v13, 0xbfb8aa3b, v64
    v_exp_f32 v13, v13
    v_mul_f32 v11, v11, v47
    v_add_f32 v13, 1.0, v13
    v_rcp_f32 v13, v13
    v_fmac_f32 v80, v11, v12
    v_mul_f32 v13, v13, v64
    v_fma_f32 v96, v80, v13, v10
    v_add_f32 v65, v65, v69
    v_add_f32 v73, v73, v77
    v_add_f32 v81, v81, v85
    v_add_f32 v89, v89, v93
    v_add_f32 v65, v65, v73
    v_add_f32 v81, v81, v89
    v_and_b32 v10, 0xffff0000, v44
    v_and_b32 v12, 0xffff0000, v48
    v_sub_f32 v11, v10, v46
    v_mul_f32 v13, 0xbfb8aa3b, v65
    v_exp_f32 v13, v13
    v_mul_f32 v11, v11, v47
    v_add_f32 v13, 1.0, v13
    v_rcp_f32 v13, v13
    v_fmac_f32 v81, v11, v12
    v_mul_f32 v13, v13, v65
    v_fma_f32 v97, v81, v13, v10
    v_add_f32 v66, v66, v70
    v_add_f32 v74, v74, v78
    v_add_f32 v82, v82, v86
    v_add_f32 v90, v90, v94
    v_add_f32 v66, v66, v74
    v_add_f32 v82, v82, v90
    v_lshlrev_b32 v10, 16, v45
    v_lshlrev_b32 v12, 16, v49
    v_sub_f32 v11, v10, v46
    v_mul_f32 v13, 0xbfb8aa3b, v66
    v_exp_f32 v13, v13
    v_mul_f32 v11, v11, v47
    v_add_f32 v13, 1.0, v13
    v_rcp_f32 v13, v13
    v_fmac_f32 v82, v11, v12
    v_mul_f32 v13, v13, v66
    v_fma_f32 v98, v82, v13, v10
    v_add_f32 v67, v67, v71
    v_add_f32 v75, v75, v79
    v_add_f32 v83, v83, v87
    v_add_f32 v91, v91, v95
    v_add_f32 v67, v67, v75
    v_add_f32 v83, v83, v91
    v_and_b32 v10, 0xffff0000, v45
    v_and_b32 v12, 0xffff0000, v49
    v_sub_f32 v11, v10, v46
    v_mul_f32 v13, 0xbfb8aa3b, v67
    v_exp_f32 v13, v13
    v_mul_f32 v11, v11, v47
    v_add_f32 v13, 1.0, v13
    v_rcp_f32 v13, v13
    v_fmac_f32 v83, v11, v12
    v_mul_f32 v13, v13, v67
    v_fma_f32 v99, v83, v13, v10
    buffer_store_dwordx4 v[96:99], v22, s[68:71], 0 offen sc1
    s_nop 1
K2_FIN:
K1_END:
    s_endpgm
.section .rodata,"a"
.p2align 6
.amdhsa_kernel recurrent_scan__ssm_conv_s5__geglu_ffn__prompt_kernel
  .amdhsa_next_free_vgpr 256
  .amdhsa_next_free_sgpr 102
  .amdhsa_accum_offset 256
  .amdhsa_group_segment_fixed_size 0
  .amdhsa_kernarg_size 128
  .amdhsa_user_sgpr_count 2
  .amdhsa_user_sgpr_kernarg_segment_ptr 1
  .amdhsa_system_sgpr_workgroup_id_x 1
.end_amdhsa_kernel
```
